```python
import torch

def _softmax(x, axis=-1):
    return torch.softmax(x, dim=axis)
def _gelu(x):
    return torch.nn.functional.gelu(x, approximate="tanh")
def _silu(x):
    return torch.nn.functional.silu(x)
def _sigmoid(x):
    return torch.sigmoid(x)
def _layernorm(x, axis=-1, eps=1e-5):
    m = x.mean(dim=axis, keepdim=True)
    v = x.var(dim=axis, keepdim=True, unbiased=False)
    return (x - m) / torch.sqrt(v + eps)
def _scatter_add(tgt, idx, src, axis=0):
    return tgt.clone().index_add_(axis, idx, src)
def _segment_sum(src, seg, n):
    out = torch.zeros((n,) + src.shape[1:], dtype=src.dtype)
    return out.index_add_(0, seg, src)
def _pad(x, pw):
    flat = tuple(v for pair in reversed(pw) for v in pair)
    return torch.nn.functional.pad(x, flat)

kernel_name = 'standalone__cheap_equivariant_egnn__graph'

def setup_inputs():

    _w = (lambda a: (lambda t: t.to(torch.bfloat16) if t.is_floating_point() else t)(torch.as_tensor(a)))
    N, deg, D, De = 25000, 16, 128, max(4, 1)
    E = N * deg
    return {
        "h": _w((lambda *s: torch.randn(*s, dtype=torch.bfloat16) * 0.2)(N, D)),
        "pos": _w((lambda *s: torch.randn(*s, dtype=torch.bfloat16) * 0.8)(N, 3)),
        "e_attr": _w((lambda *s: torch.randn(*s, dtype=torch.bfloat16) * 0.8)(E, De)),
        "src": _w((lambda lo, hi, *s: torch.randint(lo, hi, s))(0, N, E).to(torch.int64)),
        "dst": _w((lambda lo, hi, *s: torch.randint(lo, hi, s))(0, N, E).to(torch.int64)),
        "w_e": _w(0.1 * (lambda *s: torch.randn(*s, dtype=torch.bfloat16) * 0.8)(2 * D + 1 + De, D)),
        "w_x": _w(0.1 * (lambda *s: torch.randn(*s, dtype=torch.bfloat16) * 0.2)(D, 1)),
        "w_h": _w(0.1 * (lambda *s: torch.randn(*s, dtype=torch.bfloat16) * 0.2)(2 * D, D)),
    }

def reference(h, pos, e_attr, src, dst, w_e, w_x, w_h):
    N, D = h.shape[0], h.shape[1]
    diff = pos[dst] - pos[src]
    dist2 = torch.sum(diff * diff, axis=-1, keepdims=True)
    e_in = torch.concatenate([h[dst], h[src], dist2, e_attr], axis=-1)
    m_ij = _silu(e_in @ w_e)
    coord_scale = m_ij @ w_x
    pos_new = pos + _segment_sum(diff * coord_scale, dst, N)
    m_i = _segment_sum(m_ij, dst, N)
    h_new = h + _silu(torch.concatenate([h, m_i], axis=-1) @ w_h)
    return h_new, pos_new
```

```asm
; @launch grid=(256,1,1) block=(512,1,1) lds=163840
.amdgcn_target "amdgcn-amd-amdhsa--gfx950"
.text
.globl standalone__cheap_equivariant_egnn__graph_kernel
.type standalone__cheap_equivariant_egnn__graph_kernel,@function
.p2align 8
standalone__cheap_equivariant_egnn__graph_kernel:
    s_cmp_ge_u32 s2, 256
    s_cbranch_scc1 K2_END
    s_load_dwordx16 s[4:19], s[0:1], 0
    s_load_dwordx2 s[20:21], s[0:1], 64
    s_load_dwordx2 s[24:25], s[0:1], 80
    v_lshrrev_b32 v16, 6, v0
    s_getpc_b64 s[74:75]
K2_PC:
    s_and_b32 s3, s2, -8
    v_add_lshl_u32 v17, v16, s3, 6
    v_min_u32 v17, K2_END-K2_PC, v17
    global_load_dword v34, v17, s[74:75]
    v_and_b32 v1, 63, v0
    v_readfirstlane_b32 s44, v16
    s_mul_i32 s26, s2, 6272
    v_lshl_add_u32 v92, v0, 4, s26
    s_mov_b32 s79, 39936
    v_lshl_add_u32 v17, v0, 2, s79
    v_mov_b64 v[28:29], 0
    ds_write_b32 v17, v28
    v_cmp_gt_u32 vcc, 392, v0
    s_mov_b64 s[72:73], vcc
    v_cmp_gt_u32 vcc, 1600000, v92
    s_and_b64 s[72:73], s[72:73], vcc
    v_cndmask_b32 v92, 0, v92, s[72:73]
    s_or_b64 exec, s[72:73], 1
    v_lshlrev_b32 v93, 1, v92
    s_and_b32 s45, s2, 7
    s_lshl_b32 s45, s45, 5
    s_lshr_b32 s3, s2, 3
    s_add_u32 s45, s45, s3
    s_mul_i32 s46, s45, 98
    s_mov_b32 s38, 66816
    s_mov_b32 s39, 0x20000
    s_waitcnt lgkmcnt(0)
    global_load_dwordx4 v[64:67], v92, s[12:13]
    s_load_dword s22, s[24:25], 0
    s_barrier
    global_load_dwordx4 v[68:71], v92, s[10:11]
    global_load_dwordx4 v[72:75], v93, s[8:9]
    global_load_dwordx4 v[76:79], v93, s[8:9] offset:16
    s_mov_b64 exec, -1
    s_mov_b32 s36, s14
    s_mov_b32 s37, s15
    s_add_u32 s77, s44, 257
    s_cmp_lt_u32 s44, 4
    s_cselect_b32 s77, s77, 256
    s_lshl_b32 s77, s77, 8
    v_lshlrev_b32 v16, 2, v1
    buffer_load_dword v40, v16, s[36:39], s77 offen
    s_mov_b32 s60, s16
    s_mov_b32 s61, s17
    s_mov_b32 s16, s18
    s_mov_b32 s17, s19
    v_add_u32 v43, s46, v0
    s_cmp_lt_u32 s44, 2
    s_cbranch_scc1 F_A
    v_lshrrev_b32 v17, 1, v16
    v_xor_b32 v17, v17, v16
    v_and_b32 v17, 8, v17
    v_mul_u32_u24 v17, 3, v17
    v_xor_b32 v16, v16, v17
    global_load_dword v41, v16, s[60:61]
    s_mul_i32 s77, s3, 6
    s_add_u32 s77, s77, s44
    s_sub_u32 s77, s77, 2
    s_mul_i32 s77, s77, 384
    v_min_u32 v16, 2, v1
    v_lshl_add_u32 v16, v16, 7, s77
    buffer_load_dword v32, v16, s[36:39], 0 offen
    s_and_b32 s77, s2, 30
    s_lshl_b32 s77, s77, 10
    s_lshr_b32 s78, s2, 5
    s_lshl_b32 s78, s78, 5
    s_add_u32 s77, s77, s78
    s_and_b32 s78, s2, 1
    s_lshl_b32 s78, s78, 4
    s_add_u32 s77, s77, s78
    s_cmp_eq_u32 s44, 7
    s_cselect_b32 s78, 32768, 0
    s_add_u32 s77, s77, s78
    v_and_b32 v16, 7, v1
    v_lshrrev_b32 v17, 3, v1
    v_lshl_add_u32 v16, v16, 8, s77
    v_lshl_add_u32 v16, v17, 1, v16
    global_load_short_d16_hi v44, v16, s[16:17]
    s_branch F_B
F_A:
    s_mov_b32 s60, s6
    s_mov_b32 s61, s7
    s_mov_b32 s62, 150000
    s_mov_b32 s63, 0x20000
    v_mul_u32_u24 v17, 6, v43
    buffer_load_short_d16_hi v44, v17, s[60:63], 0 offen
    buffer_load_short_d16_hi v45, v17, s[60:63], 0 offen offset:2
    buffer_load_short_d16_hi v46, v17, s[60:63], 0 offen offset:4
F_B:
    s_add_u32 s77, s46, 98
    s_lshl_b32 s58, s77, 8
    s_min_u32 s34, s58, 6400000
    s_mov_b32 s32, s4
    s_mov_b32 s33, s5
    s_mov_b32 s35, 0x20000
    s_lshl_b32 s77, s44, 12
    s_add_u32 m0, s77, 135936
    s_lshl_b32 s78, s46, 8
    s_add_u32 s78, s77, s78
    v_lshrrev_b32 v16, 4, v1
    v_and_b32 v17, 15, v1
    v_xor_b32 v17, v16, v17
    v_lshlrev_b32 v17, 4, v17
    v_lshl_add_u32 v17, v16, 8, v17
    v_add_u32 v112, s78, v17
    v_xor_b32 v113, 64, v112
    v_xor_b32 v114, 128, v112
    v_xor_b32 v115, 192, v112
    v_lshlrev_b32 v108, 4, v0
    v_add_u32 v109, 8192, v108
    v_add_u32 v110, 8192, v109
    v_add_u32 v111, s79, v108
    s_mov_b32 s68, 0xbfb8aa3b
    s_mov_b32 s69, s68
    s_mov_b32 s18, 0xcbb8aa3b
    s_mov_b32 s19, s18
    v_lshlrev_b32 v17, 3, v0
    ds_write_b64 v17, v[28:29] offset:32768
    v_lshrrev_b32 v16, 4, v1
    v_and_b32 v17, 15, v1
    s_lshl_b32 s77, s44, 12
    v_lshlrev_b32 v18, 2, v16
    v_xor_b32 v18, v18, v17
    v_lshl_add_u32 v16, v16, 8, s77
    v_lshl_add_u32 v42, v18, 4, v16
    s_add_u32 s56, s24, 4096
    s_addc_u32 s57, s25, 0
    s_mov_b32 s59, 0x20000
    v_bfe_u32 v16, v1, 2, 2
    v_and_b32 v19, 3, v1
    v_lshrrev_b32 v17, 5, v1
    v_lshl_add_u32 v18, v17, 3, v16
    v_lshlrev_b32 v18, 8, v18
    v_lshl_add_u32 v18, v19, 3, v18
    v_and_b32 v19, 16, v1
    v_lshl_add_u32 v18, v19, 1, v18
    s_and_b32 s66, s44, 1
    s_lshr_b32 s27, s44, 1
    s_lshl_b32 s77, s66, 1
    v_xor_b32 v19, s77, v16
    v_lshl_add_u32 v56, v19, 6, v18
    v_add_u32 v56, 103168, v56
    v_xor_b32 v57, 64, v56
    v_and_b32 v60, 31, v1
    v_and_b32 v61, 15, v1
    v_xor_b32 v61, v17, v61
    v_lshlrev_b32 v61, 4, v61
    v_lshl_add_u32 v61, v60, 8, v61
    s_lshl_b32 s78, s27, 13
    s_add_u32 s77, s78, 135936
    v_add_u32 v48, s77, v61
    v_xor_b32 v49, 32, v48
    v_xor_b32 v50, 64, v48
    v_xor_b32 v51, 96, v48
    v_xor_b32 v52, 128, v48
    v_xor_b32 v53, 160, v48
    v_xor_b32 v54, 192, v48
    v_xor_b32 v55, 224, v48
    s_lshl_b32 s77, s46, 8
    s_add_u32 s78, s78, s77
    s_lshl_b32 s66, s66, 7
    s_add_u32 s78, s78, s66
    v_lshlrev_b32 v58, 10, v17
    v_lshl_add_u32 v58, v60, 2, v58
    v_add_u32 v58, s78, v58
    v_add_u32 v59, 4096, v58
    v_bfe_u32 v16, v1, 2, 2
    v_lshrrev_b32 v17, 4, v1
    v_lshl_add_u32 v17, v17, 3, v16
    s_lshr_b32 s77, s44, 1
    v_xor_b32 v16, s77, v16
    v_lshlrev_b32 v17, 8, v17
    v_lshl_add_u32 v17, v16, 6, v17
    v_and_b32 v16, 3, v1
    s_and_b32 s77, s44, 1
    s_lshl_b32 s77, s77, 5
    s_add_u32 s77, s77, 56848
    v_lshl_add_u32 v17, v16, 3, v17
    v_add_u32 v60, s77, v17
    v_and_b32 v16, 15, v1
    v_lshrrev_b32 v17, 4, v1
    v_xor_b32 v18, v16, v17
    v_lshlrev_b32 v18, 4, v18
    v_lshl_add_u32 v18, v16, 8, v18
    v_add_u32 v36, 135936, v18
    v_xor_b32 v37, 64, v36
    v_xor_b32 v38, 128, v36
    v_xor_b32 v39, 192, v36
    s_lshl_b32 s77, s44, 5
    s_add_u32 s77, s77, 107920
    v_cmp_gt_u32 vcc, 10, v16
    v_mul_u32_u24 v18, 264, v16
    v_lshl_add_u32 v18, v17, 3, v18
    v_add_u32 v30, s77, v18
    v_mov_b32 v18, 196608
    v_cndmask_b32 v31, v18, v30, vcc
    s_add_u32 s28, s24, 3968
    s_addc_u32 s29, s25, 0
    s_and_b32 s29, s29, 0xffff
    s_or_b32 s29, s29, 0x40000
    s_mov_b32 s30, 64
    s_mov_b32 s31, 0x800000
    s_mov_b32 s64, 0
    s_mov_b32 s65, -1
    s_mov_b32 s70, 0xbf317218
    s_mov_b32 s71, s70
    v_and_b32 v16, 31, v1
    v_lshrrev_b32 v17, 5, v1
    v_lshl_add_u32 v2, v16, 2, 16
    v_lshlrev_b32 v3, 4, v17
    v_lshlrev_b32 v10, 3, v17
    v_lshrrev_b32 v11, 2, v16
    v_and_b32 v13, 1, v11
    v_lshlrev_b32 v13, 3, v13
    v_add_u32 v13, 4849656, v13
    v_mul_u32_u24 v13, v13, v17
    v_mul_u32_u24 v15, 7, v17
    s_mul_i32 s77, s44, 2304
    s_add_u32 s77, s77, 87376
    v_mul_u32_u24 v18, 72, v16
    v_add_u32 v18, s77, v18
    v_mov_b32 v21, 196608
    v_cndmask_b32 v4, v21, v18, s[64:65]
    v_lshlrev_b32 v9, 3, v16
    v_bfe_u32 v18, v1, 2, 2
    v_and_b32 v19, 3, v1
    v_cmp_eq_u32 vcc, 0, v19
    v_lshlrev_b32 v19, 3, v19
    v_and_b32 v20, 16, v1
    v_lshl_add_u32 v19, v20, 1, v19
    v_lshl_add_u32 v20, v17, 2, v18
    v_mul_u32_u24 v5, 72, v20
    v_add3_u32 v5, v5, v19, s77
    v_mul_u32_u24 v6, 264, v20
    s_mov_b32 s77, 105808
    v_add3_u32 v6, v6, v19, s77
    v_mul_u32_u24 v7, 288, v20
    s_mov_b32 s77, 56848
    v_add3_u32 v7, v7, v19, s77
    v_mul_u32_u24 v19, 288, v11
    v_add3_u32 v19, v19, v10, s77
    v_cndmask_b32 v8, v21, v19, vcc
    v_lshrrev_b32 v19, 2, v11
    v_cmp_eq_u32 s[66:67], v19, v17
    v_mov_b32 v20, 0x3f80
    s_and_b64 vcc, vcc, s[66:67]
    v_mov_b32 v21, 0
    v_cndmask_b32 v20, 0, v20, vcc
    v_lshlrev_b32 v18, 4, v18
    v_lshlrev_b64 v[26:27], v18, v[20:21]
    s_lshr_b32 s77, s45, 2
    s_lshl_b32 s77, s77, 4
    s_and_b32 s78, s45, 1
    s_lshl_b32 s78, s78, 3
    s_add_u32 s77, s77, s78
    s_and_b32 s78, s45, 2
    s_lshl_b32 s78, s78, 9
    s_add_u32 s77, s77, s78
    s_add_u32 s77, s77, 6553600
    v_lshrrev_b32 v23, 1, v0
    v_lshl_add_u32 v12, v23, 11, s77
    s_mov_b32 s77, 7077888
    v_lshl_add_u32 v14, v23, 5, s77
    v_mul_u32_u24 v23, 18816, v23
    v_and_b32 v63, 1, v0
    v_lshlrev_b32 v63, 4, v63
    s_add_u32 s40, s24, 7274496
    s_addc_u32 s41, s25, 0
    s_mov_b32 s42, 5249664
    s_mov_b32 s43, 0x20000
    s_mul_i32 s26, s2, 18816
    s_add_u32 s52, s40, s26
    s_addc_u32 s53, s41, 0
    s_movk_i32 s54, 18816
    s_mov_b32 s55, 0x20000
    s_mov_b32 s47, 0
    s_movk_i32 s48, 128
    s_mov_b32 s51, 0
    s_mov_b32 s15, 0
    s_mov_b32 s3, 32768
    v_mov_b32 v47, 0
    v_lshlrev_b32 v43, 4, v43
    v_add_u32 v43, 4849664, v43
    v_cmp_gt_u32 vcc, 98, v0
    v_mov_b32 v16, 2130706432
    s_movk_i32 s26, -98
    v_cndmask_b32 v43, v16, v43, vcc
    v_mov_b32 v21, 4
    v_lshl_add_u32 v20, v1, 4, s79
    s_mov_b64 exec, s[72:73]
    s_waitcnt vmcnt(7)
    v_mul_u32_u24 v80, 2675, v64
    v_mul_u32_u24 v81, 2675, v65
    v_mul_u32_u24 v82, 2675, v66
    v_mul_u32_u24 v83, 2675, v67
    v_lshrrev_b32 v88, 18, v80
    v_lshrrev_b32 v89, 18, v81
    v_lshrrev_b32 v90, 18, v82
    v_lshrrev_b32 v91, 18, v83
    v_lshl_add_u32 v80, v88, 2, s79
    v_lshl_add_u32 v81, v89, 2, s79
    v_lshl_add_u32 v82, v90, 2, s79
    v_lshl_add_u32 v83, v91, 2, s79
    ds_add_rtn_u32 v84, v80, v21
    ds_add_rtn_u32 v85, v81, v21
    ds_add_rtn_u32 v86, v82, v21
    ds_add_rtn_u32 v87, v83, v21
    v_mad_i32_i24 v88, v88, s26, v64
    v_mad_i32_i24 v89, v89, s26, v65
    v_mad_i32_i24 v90, v90, s26, v66
    v_mad_i32_i24 v91, v91, s26, v67
    v_lshlrev_b32 v88, 24, v88
    v_lshlrev_b32 v89, 24, v89
    v_lshlrev_b32 v90, 24, v90
    v_lshlrev_b32 v91, 24, v91
    s_mov_b64 exec, -1
    buffer_load_dwordx4 v112, s[32:35], 0 offen offset:0 lds
    buffer_load_dwordx4 v113, s[32:35], 0 offen offset:1024 lds
    buffer_load_dwordx4 v114, s[32:35], 0 offen offset:2048 lds
    buffer_load_dwordx4 v115, s[32:35], 0 offen offset:3072 lds
    s_waitcnt lgkmcnt(0)
    s_barrier
    ds_read_b128 v[96:99], v20
    s_waitcnt lgkmcnt(0)
    v_add_u32 v101, v96, v97
    v_add_u32 v102, v101, v98
    v_add_u32 v103, v102, v99
    v_mov_b32 v104, v103
    s_nop 1
    v_add_u32_dpp v104, v104, v104 row_shr:1 row_mask:0xf bank_mask:0xf
    s_nop 1
    v_add_u32_dpp v104, v104, v104 row_shr:2 row_mask:0xf bank_mask:0xf
    s_nop 1
    v_add_u32_dpp v104, v104, v104 row_shr:4 row_mask:0xf bank_mask:0xf
    s_nop 1
    v_add_u32_dpp v104, v104, v104 row_shr:8 row_mask:0xf bank_mask:0xf
    s_nop 1
    v_add_u32_dpp v104, v104, v104 row_bcast:15 row_mask:0xa bank_mask:0xf
    s_nop 1
    v_add_u32_dpp v104, v104, v104 row_bcast:31 row_mask:0xc bank_mask:0xf
    v_sub_u32 v100, v104, v103
    v_add_u32 v103, v100, v102
    v_add_u32 v102, v100, v101
    v_add_u32 v101, v100, v96
    ds_write_b128 v20, v[100:103] offset:1024
    s_mov_b64 exec, s[72:73]
    ds_read_b32 v80, v80 offset:1024
    ds_read_b32 v81, v81 offset:1024
    ds_read_b32 v82, v82 offset:1024
    ds_read_b32 v83, v83 offset:1024
    s_waitcnt vmcnt(10)
    v_lshl_or_b32 v88, v68, 8, v88
    v_lshl_or_b32 v89, v69, 8, v89
    v_lshl_or_b32 v90, v70, 8, v90
    v_lshl_or_b32 v91, v71, 8, v91
    s_waitcnt lgkmcnt(0)
    v_add_u32 v84, v80, v84
    v_add_u32 v85, v81, v85
    v_add_u32 v86, v82, v86
    v_add_u32 v87, v83, v87
    v_add_u32 v80, s79, v84
    v_add_u32 v81, s79, v85
    v_add_u32 v82, s79, v86
    v_add_u32 v83, s79, v87
    ds_write_b32 v80, v88 offset:2048
    v_add_u32 v84, v80, v84
    ds_write_b32 v81, v89 offset:2048
    v_add_u32 v85, v81, v85
    ds_write_b32 v82, v90 offset:2048
    v_add_u32 v86, v82, v86
    ds_write_b32 v83, v91 offset:2048
    v_add_u32 v87, v83, v87
    s_waitcnt vmcnt(8)
    ds_write_b64 v84, v[72:73] offset:8320
    ds_write_b64 v85, v[74:75] offset:8320
    ds_write_b64 v86, v[76:77] offset:8320
    ds_write_b64 v87, v[78:79] offset:8320
    s_mov_b64 exec, -1
    v_lshl_or_b32 v192, v96, 16, v100
    v_lshl_or_b32 v194, v97, 16, v101
    v_lshl_or_b32 v196, v98, 16, v102
    v_lshl_or_b32 v198, v99, 16, v103
    s_waitcnt lgkmcnt(0)
    s_barrier
    ds_read_b128 v[96:99], v111 offset:2048
    ds_read_b128 v[100:103], v111 offset:10240
    ds_read_b128 v[104:107], v111 offset:18432
    s_waitcnt lgkmcnt(2)
    buffer_store_dwordx4 v[96:99], v108, s[52:55], 0 offen sc1
    s_waitcnt lgkmcnt(1)
    buffer_store_dwordx4 v[100:103], v109, s[52:55], 0 offen sc1
    s_waitcnt lgkmcnt(0)
    buffer_store_dwordx4 v[104:107], v110, s[52:55], 0 offen sc1
    s_waitcnt vmcnt(7)
    s_cmp_ge_u32 s44, 2
    s_cbranch_scc1 F_C
    buffer_store_dwordx4 v[44:47], v43, s[40:43], 0 offen sc1
    ds_write_b128 v108, v[44:47] offset:37216
    s_branch F_D
F_C:
    s_cmp_eq_u32 s44, 7
    s_cselect_b32 s77, s2, 0
    s_bitcmp1_b32 s77, 3
    s_cselect_b32 s77, 0x33000000, 1.0
    v_mul_f32 v44, s77, v44
    s_add_u32 s60, s24, 7143424
    s_addc_u32 s61, s25, 0
    s_mov_b32 s62, 65536
    s_mov_b32 s63, 0x20000
    s_sub_u32 s77, s44, 6
    s_min_u32 s77, s77, 2
    s_lshl_b32 s77, s77, 8
    s_add_u32 s77, s77, s2
    s_lshl_b32 s77, s77, 7
    v_lshl_add_u32 v16, v1, 1, s77
    buffer_store_short_d16_hi v44, v16, s[60:63], 0 offen sc1
    s_cmp_lg_u32 s44, 2
    s_cbranch_scc1 F_D
    v_lshrrev_b32 v16, 2, v1
    v_and_b32 v18, 3, v1
    v_lshrrev_b32 v19, 1, v16
    v_lshlrev_b32 v16, 4, v16
    v_mov_b32 v20, 0x3f80
    v_cmp_eq_u32 vcc, v18, v19
    v_lshlrev_b32 v20, v16, v20
    v_bfe_u32 v18, v1, 4, 1
    v_cndmask_b32 v20, 0, v20, vcc
    v_mul_i32_i24 v18, -25, v18
    v_lshlrev_b32 v16, 16, v41
    v_and_b32 v17, 0xffff0000, v41
    v_ldexp_f32 v16, v16, v18
    v_ldexp_f32 v17, v17, v18
    v_cvt_pk_bf16_f32 v41, v16, v17
    v_lshlrev_b32 v17, 2, v1
    ds_write2st64_b32 v17, v20, v41 offset0:154 offset1:155
F_D:
    s_mul_i32 s14, s22, 0x2c9277b5
    s_add_u32 s14, s14, 0xac564b05
    s_mov_b32 s66, 0xffff0000
    s_mov_b32 s67, s66
    s_cmp_lt_u32 s44, 6
    s_cselect_b32 s77, s68, 0
    s_cselect_b32 s78, s18, 0
    v_mov_b32 v18, s77
    v_mov_b32 v19, s78
    v_cndmask_b32 v18, v18, v19, s[66:67]
    s_cmp_eq_u32 s44, 5
    s_cselect_b32 s26, -1.0, 0
    s_mul_i32 s78, s44, 264
    s_add_u32 s78, s78, 105808
    v_lshlrev_b32 v16, 16, v40
    v_and_b32 v17, 0xffff0000, v40
    v_mul_f32 v16, v18, v16
    v_mul_f32 v17, v18, v17
    v_cvt_pk_bf16_f32 v18, v16, v17
    v_lshlrev_b32 v19, 16, v18
    v_and_b32 v18, 0xffff0000, v18
    v_fmac_f32 v16, s26, v19
    v_fmac_f32 v17, s26, v18
    v_cvt_pk_bf16_f32 v40, v16, v17
    v_lshl_add_u32 v43, v1, 2, s78
    s_mov_b32 s26, 0x07060302
    s_mov_b32 s77, 0xfff7fff8
    v_mul_lo_u32 v128, v0, s77
    v_subrev_u32 v129, 0x20002, v128
    v_subrev_u32 v130, 0x40004, v128
    v_subrev_u32 v131, 0x60006, v128
    ds_write_b128 v108, v[128:131] offset:0
    v_subrev_u32 v132, 0x10001000, v128
    v_subrev_u32 v133, 0x20002, v132
    v_subrev_u32 v134, 0x40004, v132
    v_subrev_u32 v135, 0x60006, v132
    ds_write_b128 v108, v[132:135] offset:8192
    v_subrev_u32 v128, 0x10001000, v132
    v_subrev_u32 v129, 0x20002, v128
    v_subrev_u32 v130, 0x40004, v128
    v_subrev_u32 v131, 0x60006, v128
    ds_write_b128 v108, v[128:131] offset:16384
    v_lshlrev_b32 v16, 19, v0
    s_mov_b32 s66, 0xb3800000
    s_mov_b32 s67, s66
    v_sub_u32 v136, 0x50000000, v16
    v_sub_u32 v137, 0x4fff0000, v16
    v_sub_u32 v138, 0x4ffe0000, v16
    v_sub_u32 v139, 0x4ffd0000, v16
    v_sub_u32 v140, 0x4ffc0000, v16
    v_sub_u32 v141, 0x4ffb0000, v16
    v_sub_u32 v142, 0x4ffa0000, v16
    v_sub_u32 v143, 0x4ff90000, v16
    v_pk_mul_f32 v[144:145], v[136:137], s[66:67]
    v_pk_mul_f32 v[146:147], v[138:139], s[66:67]
    v_pk_mul_f32 v[148:149], v[140:141], s[66:67]
    v_pk_mul_f32 v[150:151], v[142:143], s[66:67]
    v_exp_f32 v144, v144
    v_exp_f32 v145, v145
    v_exp_f32 v146, v146
    v_exp_f32 v147, v147
    v_exp_f32 v148, v148
    v_exp_f32 v149, v149
    v_exp_f32 v150, v150
    v_exp_f32 v151, v151
    v_pk_add_f32 v[152:153], v[144:145], 1.0 op_sel_hi:[1,0]
    v_pk_add_f32 v[154:155], v[146:147], 1.0 op_sel_hi:[1,0]
    v_pk_add_f32 v[156:157], v[148:149], 1.0 op_sel_hi:[1,0]
    v_pk_add_f32 v[158:159], v[150:151], 1.0 op_sel_hi:[1,0]
    v_rcp_f32 v152, v152
    v_rcp_f32 v153, v153
    v_rcp_f32 v154, v154
    v_rcp_f32 v155, v155
    v_rcp_f32 v156, v156
    v_rcp_f32 v157, v157
    v_rcp_f32 v158, v158
    v_rcp_f32 v159, v159
    v_pk_add_f32 v[144:145], v[144:145], -1.0 op_sel_hi:[1,0]
    v_pk_add_f32 v[146:147], v[146:147], -1.0 op_sel_hi:[1,0]
    v_pk_add_f32 v[148:149], v[148:149], -1.0 op_sel_hi:[1,0]
    v_pk_add_f32 v[150:151], v[150:151], -1.0 op_sel_hi:[1,0]
    v_pk_mul_f32 v[144:145], v[144:145], v[152:153]
    v_pk_mul_f32 v[146:147], v[146:147], v[154:155]
    v_pk_mul_f32 v[148:149], v[148:149], v[156:157]
    v_pk_mul_f32 v[150:151], v[150:151], v[158:159]
    v_pk_mul_f32 v[144:145], v[144:145], v[136:137]
    v_pk_mul_f32 v[146:147], v[146:147], v[138:139]
    v_pk_mul_f32 v[148:149], v[148:149], v[140:141]
    v_pk_mul_f32 v[150:151], v[150:151], v[142:143]
    v_cvt_pk_bf16_f32 v136, v144, v145
    v_cvt_pk_bf16_f32 v137, v146, v147
    v_cvt_pk_bf16_f32 v138, v148, v149
    v_cvt_pk_bf16_f32 v139, v150, v151
    ds_write_b128 v108, v[136:139] offset:24576
    s_lshl_b32 s77, s44, 12
    s_add_u32 m0, s77, 103168
    s_nop 0
    buffer_load_dwordx4 v42, s[36:39], s3 offen offset:0 lds
    buffer_load_dwordx4 v42, s[36:39], s3 offen offset:1024 lds
    buffer_load_dwordx4 v42, s[36:39], s3 offen offset:2048 lds
    buffer_load_dwordx4 v42, s[36:39], s3 offen offset:3072 lds
    s_waitcnt vmcnt(0) lgkmcnt(0)
    s_barrier
    s_cmp_lg_u32 s44, 7
    s_cbranch_scc1 F_4
    s_lshl_b32 s77, s2, 11
    s_add_u32 s77, s77, 6553600
    v_lshl_add_u32 v16, v1, 4, s77
    v_mov_b32 v193, s14
    v_mov_b32 v195, s14
    v_mov_b32 v197, s14
    v_mov_b32 v199, s14
    global_store_dwordx4 v16, v[192:195], s[24:25] sc1
    global_store_dwordx4 v16, v[196:199], s[24:25] offset:1024 sc1
F_4:
    ds_read_b128 v[64:67], v48
    ds_read_b64_tr_b16 v[128:129], v56 offset:0
    ds_read_b64_tr_b16 v[130:131], v56 offset:1024
    ds_read_b64_tr_b16 v[132:133], v57 offset:0
    ds_read_b64_tr_b16 v[134:135], v57 offset:1024
    ds_read_b128 v[68:71], v49
    ds_read_b64_tr_b16 v[136:137], v56 offset:4096
    ds_read_b64_tr_b16 v[138:139], v56 offset:5120
    ds_read_b64_tr_b16 v[140:141], v57 offset:4096
    ds_read_b64_tr_b16 v[142:143], v57 offset:5120
    ds_read_b128 v[72:75], v50
    ds_read_b64_tr_b16 v[144:145], v56 offset:8192
    ds_read_b64_tr_b16 v[146:147], v56 offset:9216
    ds_read_b64_tr_b16 v[148:149], v57 offset:8192
    ds_read_b64_tr_b16 v[150:151], v57 offset:9216
    s_waitcnt lgkmcnt(10)
    v_mfma_f32_32x32x16_bf16 v[224:239], v[64:67], v[128:131], 0
    v_mfma_f32_32x32x16_bf16 v[240:255], v[64:67], v[132:135], 0
    ds_read_b128 v[76:79], v51
    ds_read_b64_tr_b16 v[152:153], v56 offset:12288
    ds_read_b64_tr_b16 v[154:155], v56 offset:13312
    ds_read_b64_tr_b16 v[156:157], v57 offset:12288
    ds_read_b64_tr_b16 v[158:159], v57 offset:13312
    s_lshl_b32 s77, s44, 12
    s_add_u32 m0, s77, 56848
    s_nop 0
    buffer_load_dwordx4 v42, s[36:39], 0 offen offset:0 lds
    s_waitcnt lgkmcnt(10)
    v_mfma_f32_32x32x16_bf16 v[224:239], v[68:71], v[136:139], v[224:239]
    v_mfma_f32_32x32x16_bf16 v[240:255], v[68:71], v[140:143], v[240:255]
    ds_read_b128 v[80:83], v52
    ds_read_b64_tr_b16 v[160:161], v56 offset:16384
    ds_read_b64_tr_b16 v[162:163], v56 offset:17408
    ds_read_b64_tr_b16 v[164:165], v57 offset:16384
    ds_read_b64_tr_b16 v[166:167], v57 offset:17408
    buffer_load_dwordx4 v42, s[36:39], 0 offen offset:1024 lds
    s_waitcnt lgkmcnt(10)
    v_mfma_f32_32x32x16_bf16 v[224:239], v[72:75], v[144:147], v[224:239]
    v_mfma_f32_32x32x16_bf16 v[240:255], v[72:75], v[148:151], v[240:255]
    ds_read_b128 v[84:87], v53
    ds_read_b64_tr_b16 v[168:169], v56 offset:20480
    ds_read_b64_tr_b16 v[170:171], v56 offset:21504
    ds_read_b64_tr_b16 v[172:173], v57 offset:20480
    ds_read_b64_tr_b16 v[174:175], v57 offset:21504
    buffer_load_dwordx4 v42, s[36:39], 0 offen offset:2048 lds
    s_waitcnt lgkmcnt(10)
    v_mfma_f32_32x32x16_bf16 v[224:239], v[76:79], v[152:155], v[224:239]
    v_mfma_f32_32x32x16_bf16 v[240:255], v[76:79], v[156:159], v[240:255]
    ds_read_b128 v[88:91], v54
    ds_read_b64_tr_b16 v[176:177], v56 offset:24576
    ds_read_b64_tr_b16 v[178:179], v56 offset:25600
    ds_read_b64_tr_b16 v[180:181], v57 offset:24576
    ds_read_b64_tr_b16 v[182:183], v57 offset:25600
    buffer_load_dwordx4 v42, s[36:39], 0 offen offset:3072 lds
    s_waitcnt lgkmcnt(10)
    v_mfma_f32_32x32x16_bf16 v[224:239], v[80:83], v[160:163], v[224:239]
    v_mfma_f32_32x32x16_bf16 v[240:255], v[80:83], v[164:167], v[240:255]
    ds_read_b128 v[92:95], v55
    ds_read_b64_tr_b16 v[184:185], v56 offset:28672
    ds_read_b64_tr_b16 v[186:187], v56 offset:29696
    ds_read_b64_tr_b16 v[188:189], v57 offset:28672
    ds_read_b64_tr_b16 v[190:191], v57 offset:29696
    s_waitcnt lgkmcnt(10)
    v_mfma_f32_32x32x16_bf16 v[224:239], v[84:87], v[168:171], v[224:239]
    v_mfma_f32_32x32x16_bf16 v[240:255], v[84:87], v[172:175], v[240:255]
    s_waitcnt lgkmcnt(5)
    v_mfma_f32_32x32x16_bf16 v[224:239], v[88:91], v[176:179], v[224:239]
    v_mfma_f32_32x32x16_bf16 v[240:255], v[88:91], v[180:183], v[240:255]
    s_waitcnt lgkmcnt(0)
    v_mfma_f32_32x32x16_bf16 v[224:239], v[92:95], v[184:187], v[224:239]
    v_mfma_f32_32x32x16_bf16 v[240:255], v[92:95], v[188:191], v[240:255]
    s_nop 10
    s_cmp_eq_u32 s27, 3
    v_pk_mul_f32 v[240:241], v[240:241], s[18:19]
    v_pk_mul_f32 v[224:225], v[224:225], s[68:69]
    v_add_u32 v240, 0x4000, v240
    v_add_u32 v241, 0x4000, v241
    v_perm_b32 v224, v224, v240, s26
    v_perm_b32 v225, v225, v241, s26
    buffer_store_dword v224, v58, s[56:59], 0 offen offset:0 sc1
    buffer_store_dword v225, v58, s[56:59], 0 offen offset:256 sc1
    s_cbranch_scc1 F_5
    v_pk_mul_f32 v[242:243], v[242:243], s[18:19]
    v_pk_mul_f32 v[226:227], v[226:227], s[68:69]
    v_add_u32 v242, 0x4000, v242
    v_add_u32 v243, 0x4000, v243
    v_perm_b32 v226, v226, v242, s26
    v_perm_b32 v227, v227, v243, s26
    buffer_store_dword v226, v58, s[56:59], 0 offen offset:512 sc1
    buffer_store_dword v227, v58, s[56:59], 0 offen offset:768 sc1
    v_pk_mul_f32 v[244:245], v[244:245], s[18:19]
    v_pk_mul_f32 v[228:229], v[228:229], s[68:69]
    v_add_u32 v244, 0x4000, v244
    v_add_u32 v245, 0x4000, v245
    v_perm_b32 v228, v228, v244, s26
    v_perm_b32 v229, v229, v245, s26
    buffer_store_dword v228, v58, s[56:59], 0 offen offset:2048 sc1
    buffer_store_dword v229, v58, s[56:59], 0 offen offset:2304 sc1
    v_pk_mul_f32 v[246:247], v[246:247], s[18:19]
    v_pk_mul_f32 v[230:231], v[230:231], s[68:69]
    v_add_u32 v246, 0x4000, v246
    v_add_u32 v247, 0x4000, v247
    v_perm_b32 v230, v230, v246, s26
    v_perm_b32 v231, v231, v247, s26
    buffer_store_dword v230, v58, s[56:59], 0 offen offset:2560 sc1
    buffer_store_dword v231, v58, s[56:59], 0 offen offset:2816 sc1
    v_pk_mul_f32 v[248:249], v[248:249], s[18:19]
    v_pk_mul_f32 v[232:233], v[232:233], s[68:69]
    v_add_u32 v248, 0x4000, v248
    v_add_u32 v249, 0x4000, v249
    v_perm_b32 v232, v232, v248, s26
    v_perm_b32 v233, v233, v249, s26
    buffer_store_dword v232, v59, s[56:59], 0 offen offset:0 sc1
    buffer_store_dword v233, v59, s[56:59], 0 offen offset:256 sc1
    v_pk_mul_f32 v[250:251], v[250:251], s[18:19]
    v_pk_mul_f32 v[234:235], v[234:235], s[68:69]
    v_add_u32 v250, 0x4000, v250
    v_add_u32 v251, 0x4000, v251
    v_perm_b32 v234, v234, v250, s26
    v_perm_b32 v235, v235, v251, s26
    buffer_store_dword v234, v59, s[56:59], 0 offen offset:512 sc1
    buffer_store_dword v235, v59, s[56:59], 0 offen offset:768 sc1
    v_pk_mul_f32 v[252:253], v[252:253], s[18:19]
    v_pk_mul_f32 v[236:237], v[236:237], s[68:69]
    v_add_u32 v252, 0x4000, v252
    v_add_u32 v253, 0x4000, v253
    v_perm_b32 v236, v236, v252, s26
    v_perm_b32 v237, v237, v253, s26
    buffer_store_dword v236, v59, s[56:59], 0 offen offset:2048 sc1
    buffer_store_dword v237, v59, s[56:59], 0 offen offset:2304 sc1
    v_pk_mul_f32 v[254:255], v[254:255], s[18:19]
    v_pk_mul_f32 v[238:239], v[238:239], s[68:69]
    v_add_u32 v254, 0x4000, v254
    v_add_u32 v255, 0x4000, v255
    v_perm_b32 v238, v238, v254, s26
    v_perm_b32 v239, v239, v255, s26
    buffer_store_dword v238, v59, s[56:59], 0 offen offset:2560 sc1
    buffer_store_dword v239, v59, s[56:59], 0 offen offset:2816 sc1
    s_waitcnt vmcnt(16)
    s_branch F_6
F_5:
    s_waitcnt vmcnt(2)
F_6:
    s_barrier
    ds_read_b64_tr_b16 v[128:129], v60 offset:0
    ds_read_b64_tr_b16 v[130:131], v60 offset:1024
    ds_read_b64_tr_b16 v[132:133], v60 offset:8192
    ds_read_b64_tr_b16 v[134:135], v60 offset:9216
    ds_read_b64_tr_b16 v[136:137], v60 offset:16384
    ds_read_b64_tr_b16 v[138:139], v60 offset:17408
    ds_read_b64_tr_b16 v[140:141], v60 offset:24576
    ds_read_b64_tr_b16 v[142:143], v60 offset:25600
    ds_write_b32 v43, v40
    s_bitcmp1_b32 s44, 1
    s_cselect_b32 s3, s18, s68
    ds_read_b128 v[160:163], v36 offset:0
    ds_read_b128 v[164:167], v37 offset:0
    ds_read_b128 v[168:171], v38 offset:0
    ds_read_b128 v[172:175], v39 offset:0
    ds_read_b128 v[176:179], v36 offset:4096
    ds_read_b128 v[180:183], v37 offset:4096
    ds_read_b128 v[184:187], v38 offset:4096
    ds_read_b128 v[188:191], v39 offset:4096
    ds_read_b128 v[224:227], v36 offset:8192
    ds_read_b128 v[228:231], v37 offset:8192
    ds_read_b128 v[232:235], v38 offset:8192
    ds_read_b128 v[236:239], v39 offset:8192
    ds_read_b128 v[96:99], v36 offset:12288
    ds_read_b128 v[100:103], v37 offset:12288
    ds_read_b128 v[104:107], v38 offset:12288
    ds_read_b128 v[108:111], v39 offset:12288
    s_waitcnt lgkmcnt(8)
    v_mfma_f32_16x16x32_bf16 v[112:115], v[128:131], v[160:163], 0
    ds_read_b128 v[160:163], v36 offset:16384
    v_mfma_f32_16x16x32_bf16 v[116:119], v[128:131], v[176:179], 0
    ds_read_b128 v[176:179], v36 offset:20480
    v_mfma_f32_16x16x32_bf16 v[112:115], v[132:135], v[164:167], v[112:115]
    ds_read_b128 v[164:167], v37 offset:16384
    v_mfma_f32_16x16x32_bf16 v[116:119], v[132:135], v[180:183], v[116:119]
    ds_read_b128 v[180:183], v37 offset:20480
    v_mfma_f32_16x16x32_bf16 v[112:115], v[136:139], v[168:171], v[112:115]
    ds_read_b128 v[168:171], v38 offset:16384
    v_mfma_f32_16x16x32_bf16 v[116:119], v[136:139], v[184:187], v[116:119]
    ds_read_b128 v[184:187], v38 offset:20480
    v_mfma_f32_16x16x32_bf16 v[112:115], v[140:143], v[172:175], v[112:115]
    ds_read_b128 v[172:175], v39 offset:16384
    v_mfma_f32_16x16x32_bf16 v[116:119], v[140:143], v[188:191], v[116:119]
    ds_read_b128 v[188:191], v39 offset:20480
    global_load_dwordx2 v[24:25], v12, s[24:25] sc1
    s_waitcnt lgkmcnt(8)
    v_mfma_f32_16x16x32_bf16 v[120:123], v[128:131], v[224:227], 0
    ds_read_b128 v[224:227], v36 offset:24576
    v_mfma_f32_16x16x32_bf16 v[124:127], v[128:131], v[96:99], 0
    v_mfma_f32_16x16x32_bf16 v[120:123], v[132:135], v[228:231], v[120:123]
    ds_read_b128 v[228:231], v37 offset:24576
    v_mfma_f32_16x16x32_bf16 v[124:127], v[132:135], v[100:103], v[124:127]
    v_mul_f32 v112, s3, v112
    v_mul_f32 v113, s3, v113
    v_mul_f32 v114, s3, v114
    v_mfma_f32_16x16x32_bf16 v[120:123], v[136:139], v[232:235], v[120:123]
    ds_read_b128 v[232:235], v38 offset:24576
    v_mul_f32 v115, s3, v115
    v_cvt_pk_bf16_f32 v112, v112, v113
    v_cvt_pk_bf16_f32 v113, v114, v115
    v_mfma_f32_16x16x32_bf16 v[124:127], v[136:139], v[104:107], v[124:127]
    ds_write_b64 v30, v[112:113] offset:0
    v_mul_f32 v116, s3, v116
    v_mul_f32 v117, s3, v117
    v_mfma_f32_16x16x32_bf16 v[120:123], v[140:143], v[236:239], v[120:123]
    ds_read_b128 v[236:239], v39 offset:24576
    v_mul_f32 v118, s3, v118
    v_mul_f32 v119, s3, v119
    v_cvt_pk_bf16_f32 v116, v116, v117
    v_mfma_f32_16x16x32_bf16 v[124:127], v[140:143], v[108:111], v[124:127]
    v_cvt_pk_bf16_f32 v117, v118, v119
    ds_write_b64 v30, v[116:117] offset:4224
    s_waitcnt lgkmcnt(6)
    v_mfma_f32_16x16x32_bf16 v[112:115], v[128:131], v[160:163], 0
    v_mfma_f32_16x16x32_bf16 v[116:119], v[128:131], v[176:179], 0
    v_mfma_f32_16x16x32_bf16 v[112:115], v[132:135], v[164:167], v[112:115]
    v_mfma_f32_16x16x32_bf16 v[116:119], v[132:135], v[180:183], v[116:119]
    v_mul_f32 v120, s3, v120
    v_mul_f32 v121, s3, v121
    v_mul_f32 v122, s3, v122
    v_mfma_f32_16x16x32_bf16 v[112:115], v[136:139], v[168:171], v[112:115]
    v_mul_f32 v123, s3, v123
    v_cvt_pk_bf16_f32 v120, v120, v121
    v_cvt_pk_bf16_f32 v121, v122, v123
    v_mfma_f32_16x16x32_bf16 v[116:119], v[136:139], v[184:187], v[116:119]
    ds_write_b64 v30, v[120:121] offset:8448
    v_mul_f32 v124, s3, v124
    v_mul_f32 v125, s3, v125
    v_mfma_f32_16x16x32_bf16 v[112:115], v[140:143], v[172:175], v[112:115]
    v_mul_f32 v126, s3, v126
    v_mul_f32 v127, s3, v127
    v_cvt_pk_bf16_f32 v124, v124, v125
    v_mfma_f32_16x16x32_bf16 v[116:119], v[140:143], v[188:191], v[116:119]
    v_cvt_pk_bf16_f32 v125, v126, v127
    ds_write_b64 v30, v[124:125] offset:12672
    s_branch K2_B1
K2_B0:
    global_load_dwordx2 v[24:25], v12, s[24:25] sc1
K2_B1:
    s_add_u32 s15, s15, 1
    s_waitcnt vmcnt(0)
    v_cmp_ne_u32 vcc, s14, v25
    s_cmp_gt_u32 s15, 40000
    s_cbranch_scc1 K2_B2
    s_mov_b64 exec, vcc
    s_cbranch_execnz K2_B0
K2_B2:
    s_mov_b64 exec, -1
    v_and_b32 v16, 0xffff, v24
    v_lshrrev_b32 v22, 16, v24
    v_add3_u32 v16, v16, v63, s47
    v_subrev_u32 v22, s47, v22
    v_add_u32 v23, v23, v16
    global_load_dwordx4 v[64:67], v23, s[40:41] sc1
    v_cmp_lt_i32 s[26:27], s48, v22
    v_min_i32 v22, s48, v22
    v_sub_u32 v22, v22, v63
    v_cmp_lt_i32 vcc, 32, v22
    s_mov_b64 exec, vcc
    s_cbranch_execz K2_B3
    global_load_dwordx4 v[68:71], v23, s[40:41] offset:32 sc1
    v_cmp_lt_i32 vcc, 64, v22
    s_mov_b64 exec, vcc
    s_cbranch_execz K2_B3
    global_load_dwordx4 v[72:75], v23, s[40:41] offset:64 sc1
    global_load_dwordx4 v[76:79], v23, s[40:41] offset:96 sc1
K2_B3:
    s_mov_b64 exec, -1
    s_movk_i32 s77, 6272
    v_add3_u32 v23, v23, v16, s77
    s_cmp_lg_u32 s51, 0
    s_cbranch_scc1 K2_B4
    s_mov_b32 s51, 1
    s_barrier
    s_cmp_lg_u32 s44, 7
    s_cbranch_scc1 F_7
    s_lshl_b32 s77, s2, 5
    s_add_u32 s77, s77, 7077888
    v_mov_b32 v16, s77
    v_mov_b32 v17, s14
    s_mov_b64 exec, 1
    global_store_dword v16, v17, s[24:25] sc1
    s_cmp_lg_u32 s2, 255
    s_cbranch_scc1 F_8
    global_store_dword v28, v17, s[24:25] offset:0 sc1
F_8:
    s_mov_b64 exec, -1
F_7:
    s_waitcnt lgkmcnt(3)
    v_mfma_f32_16x16x32_bf16 v[120:123], v[128:131], v[224:227], 0
    v_mfma_f32_16x16x32_bf16 v[120:123], v[132:135], v[228:231], v[120:123]
    v_mfma_f32_16x16x32_bf16 v[120:123], v[136:139], v[232:235], v[120:123]
    v_mfma_f32_16x16x32_bf16 v[120:123], v[140:143], v[236:239], v[120:123]
    v_mul_f32 v112, s3, v112
    v_mul_f32 v113, s3, v113
    v_mul_f32 v114, s3, v114
    v_mul_f32 v115, s3, v115
    v_cvt_pk_bf16_f32 v112, v112, v113
    v_cvt_pk_bf16_f32 v113, v114, v115
    ds_write_b64 v30, v[112:113] offset:16896
    v_mul_f32 v116, s3, v116
    v_mul_f32 v117, s3, v117
    v_mul_f32 v118, s3, v118
    v_mul_f32 v119, s3, v119
    v_cvt_pk_bf16_f32 v116, v116, v117
    v_cvt_pk_bf16_f32 v117, v118, v119
    ds_write_b64 v30, v[116:117] offset:21120
    v_mul_f32 v120, s3, v120
    v_mul_f32 v121, s3, v121
    v_mul_f32 v122, s3, v122
    v_mul_f32 v123, s3, v123
    v_cvt_pk_bf16_f32 v120, v120, v121
    v_cvt_pk_bf16_f32 v121, v122, v123
    ds_write_b64 v31, v[120:121] offset:25344
    v_lshlrev_b32 v108, 4, v0
    v_mov_b64 v[220:221], 0
    v_mov_b64 v[222:223], 0
    v_add_u32 v16, 56656, v108
    ds_write_b128 v16, v[220:223] offset:0
    ds_write_b128 v16, v[220:223] offset:8192
    ds_write_b128 v16, v[220:223] offset:16384
    ds_write_b128 v16, v[220:223] offset:24576
    ds_write_b128 v16, v[220:223] offset:32768
    ds_write_b128 v16, v[220:223] offset:40960
    s_lshl_b32 s77, s44, 12
    s_add_u32 s77, s77, 7143424
    v_lshl_add_u32 v20, v1, 4, s77
    global_load_dwordx4 v[144:147], v20, s[24:25] offset:0 sc1
    global_load_dwordx4 v[148:151], v20, s[24:25] offset:1024 sc1
    global_load_dwordx4 v[152:155], v20, s[24:25] offset:2048 sc1
    global_load_dwordx4 v[156:159], v20, s[24:25] offset:3072 sc1
    global_load_dword v32, v23, s[40:41] sc1
    s_lshr_b32 s77, s2, 3
    s_lshl_b32 s77, s77, 3
    s_add_u32 s77, s77, s44
    s_mul_i32 s77, s77, 1664
    s_add_u32 s77, s77, 4849664
    v_lshl_add_u32 v20, v1, 7, s77
    s_mov_b64 exec, 0x1fff
    global_load_dword v32, v20, s[40:41] sc1
    s_mov_b64 exec, -1
    s_waitcnt vmcnt(6)
    s_branch K2_B5
K2_B4:
    s_waitcnt vmcnt(0)
K2_B5:
    v_mov_b32 v17, 32
    v_lshrrev_b32 v23, 3, v23
    s_cmp_eq_u64 s[26:27], 0
    s_cbranch_scc1 K2_B6
    ds_write_b32 v28, v17 offset:36640
K2_B6:
    v_cmpx_lt_i32 vcc, 0, v22
    v_lshlrev_b32_sdwa v96, 2, v64 dst_sel:DWORD dst_unused:UNUSED_PAD src0_sel:DWORD src1_sel:BYTE_3
    v_lshlrev_b32_sdwa v97, 2, v65 dst_sel:DWORD dst_unused:UNUSED_PAD src0_sel:DWORD src1_sel:BYTE_3
    v_lshlrev_b32_sdwa v98, 2, v66 dst_sel:DWORD dst_unused:UNUSED_PAD src0_sel:DWORD src1_sel:BYTE_3
    v_lshlrev_b32_sdwa v99, 2, v67 dst_sel:DWORD dst_unused:UNUSED_PAD src0_sel:DWORD src1_sel:BYTE_3
    ds_add_rtn_u32 v80, v96, v17 offset:36128
    v_cmpx_lt_i32 vcc, 4, v22
    ds_add_rtn_u32 v81, v97, v17 offset:36128
    v_cmpx_lt_i32 vcc, 8, v22
    ds_add_rtn_u32 v82, v98, v17 offset:36128
    v_cmpx_lt_i32 vcc, 12, v22
    ds_add_rtn_u32 v83, v99, v17 offset:36128
    v_cmpx_lt_i32 vcc, 32, v22
    v_lshlrev_b32_sdwa v100, 2, v68 dst_sel:DWORD dst_unused:UNUSED_PAD src0_sel:DWORD src1_sel:BYTE_3
    v_lshlrev_b32_sdwa v101, 2, v69 dst_sel:DWORD dst_unused:UNUSED_PAD src0_sel:DWORD src1_sel:BYTE_3
    v_lshlrev_b32_sdwa v102, 2, v70 dst_sel:DWORD dst_unused:UNUSED_PAD src0_sel:DWORD src1_sel:BYTE_3
    v_lshlrev_b32_sdwa v103, 2, v71 dst_sel:DWORD dst_unused:UNUSED_PAD src0_sel:DWORD src1_sel:BYTE_3
    ds_add_rtn_u32 v84, v100, v17 offset:36128
    v_cmpx_lt_i32 vcc, 36, v22
    ds_add_rtn_u32 v85, v101, v17 offset:36128
    v_cmpx_lt_i32 vcc, 40, v22
    s_cbranch_execz K2_B7
    ds_add_rtn_u32 v86, v102, v17 offset:36128
    v_cmpx_lt_i32 vcc, 44, v22
    ds_add_rtn_u32 v87, v103, v17 offset:36128
    v_cmpx_lt_i32 vcc, 64, v22
    s_cbranch_execz K2_B7
    v_lshlrev_b32_sdwa v104, 2, v72 dst_sel:DWORD dst_unused:UNUSED_PAD src0_sel:DWORD src1_sel:BYTE_3
    v_lshlrev_b32_sdwa v105, 2, v73 dst_sel:DWORD dst_unused:UNUSED_PAD src0_sel:DWORD src1_sel:BYTE_3
    v_lshlrev_b32_sdwa v106, 2, v74 dst_sel:DWORD dst_unused:UNUSED_PAD src0_sel:DWORD src1_sel:BYTE_3
    v_lshlrev_b32_sdwa v107, 2, v75 dst_sel:DWORD dst_unused:UNUSED_PAD src0_sel:DWORD src1_sel:BYTE_3
    ds_add_rtn_u32 v88, v104, v17 offset:36128
    v_cmpx_lt_i32 vcc, 68, v22
    ds_add_rtn_u32 v89, v105, v17 offset:36128
    v_cmpx_lt_i32 vcc, 72, v22
    ds_add_rtn_u32 v90, v106, v17 offset:36128
    v_cmpx_lt_i32 vcc, 76, v22
    ds_add_rtn_u32 v91, v107, v17 offset:36128
    v_cmpx_lt_i32 vcc, 96, v22
    s_cbranch_execz K2_B7
    v_lshlrev_b32_sdwa v108, 2, v76 dst_sel:DWORD dst_unused:UNUSED_PAD src0_sel:DWORD src1_sel:BYTE_3
    v_lshlrev_b32_sdwa v109, 2, v77 dst_sel:DWORD dst_unused:UNUSED_PAD src0_sel:DWORD src1_sel:BYTE_3
    v_lshlrev_b32_sdwa v110, 2, v78 dst_sel:DWORD dst_unused:UNUSED_PAD src0_sel:DWORD src1_sel:BYTE_3
    v_lshlrev_b32_sdwa v111, 2, v79 dst_sel:DWORD dst_unused:UNUSED_PAD src0_sel:DWORD src1_sel:BYTE_3
    ds_add_rtn_u32 v92, v108, v17 offset:36128
    v_cmpx_lt_i32 vcc, 100, v22
    ds_add_rtn_u32 v93, v109, v17 offset:36128
    v_cmpx_lt_i32 vcc, 104, v22
    ds_add_rtn_u32 v94, v110, v17 offset:36128
    v_cmpx_lt_i32 vcc, 108, v22
    ds_add_rtn_u32 v95, v111, v17 offset:36128
K2_B7:
    s_mov_b64 exec, -1
    v_lshlrev_b32 v16, 3, v1
    s_mov_b32 s78, 0xff000000
    s_mov_b32 s60, s40
    s_or_b32 s61, s41, 0x80000
    s_mov_b32 s62, 606208
    s_mov_b32 s63, 0x20000
    s_waitcnt lgkmcnt(0)
    s_barrier
    ds_read_b64 v[18:19], v16 offset:36128
    ds_read_b32 v17, v28 offset:36640
    global_load_dword v24, v14, s[24:25] sc1
    v_add_u32 v112, 0, v23
    v_and_or_b32 v112, v64, s78, v112
    v_add_u32 v113, 1, v23
    v_and_or_b32 v113, v65, s78, v113
    s_waitcnt lgkmcnt(0)
    v_add_u32 v19, v18, v19
    v_readfirstlane_b32 s50, v17
    v_mov_b32 v21, v19
    v_subrev_u32 v19, 128, v19
    v_add_u32 v114, 2, v23
    v_and_or_b32 v114, v66, s78, v114
    v_add_u32_dpp v21, v21, v21 row_shr:1 row_mask:0xf bank_mask:0xf
    v_add_u32 v115, 3, v23
    v_and_or_b32 v115, v67, s78, v115
    v_add_u32_dpp v21, v21, v21 row_shr:2 row_mask:0xf bank_mask:0xf
    v_add_u32 v116, 8, v23
    v_and_or_b32 v116, v68, s78, v116
    v_add_u32_dpp v21, v21, v21 row_shr:4 row_mask:0xf bank_mask:0xf
    v_add_u32 v117, 9, v23
    v_and_or_b32 v117, v69, s78, v117
    v_add_u32_dpp v21, v21, v21 row_shr:8 row_mask:0xf bank_mask:0xf
    v_add_u32 v118, 10, v23
    v_and_or_b32 v118, v70, s78, v118
    v_add_u32_dpp v21, v21, v21 row_bcast:15 row_mask:0xa bank_mask:0xf
    v_add_u32 v119, 11, v23
    v_and_or_b32 v119, v71, s78, v119
    v_add_u32_dpp v21, v21, v21 row_bcast:31 row_mask:0xc bank_mask:0xf
    v_sub_u32 v48, v21, v19
    v_readlane_b32 s49, v21, 63
    v_add_u32 v49, v48, v18
    ds_write_b64 v16, v[48:49] offset:36704
    v_cmpx_lt_i32 vcc, 0, v22
    ds_read_b32 v96, v96 offset:36704
    ds_read_b32 v97, v97 offset:36704
    ds_read_b32 v98, v98 offset:36704
    ds_read_b32 v99, v99 offset:36704
    v_cmpx_lt_i32 vcc, 32, v22
    ds_read_b32 v100, v100 offset:36704
    ds_read_b32 v101, v101 offset:36704
    ds_read_b32 v102, v102 offset:36704
    ds_read_b32 v103, v103 offset:36704
    s_mov_b64 exec, -1
    s_lshr_b32 s49, s49, 3
    s_cmp_gt_u32 s49, 8192
    s_cbranch_scc0 K2_B8
    s_mov_b32 s48, 32
    s_branch K2_AGAIN
K2_B8:
    s_add_u32 s77, s49, 127
    s_lshr_b32 s77, s77, 7
    s_lshl_b32 s54, s77, 7
    s_lshr_b32 s3, s77, 3
    s_and_b32 s77, s77, 7
    s_mul_i32 s52, s3, s44
    s_min_u32 s79, s77, s44
    s_add_u32 s52, s52, s79
    s_cmp_lt_u32 s44, s77
    s_addc_u32 s76, s3, 0
    s_and_b32 s79, s44, 3
    s_cmp_lt_u32 s79, s77
    s_addc_u32 s79, s3, 0
    s_cmp_eq_u32 s79, s76
    s_cselect_b32 s10, 4, 8
    s_add_u32 s53, s52, s76
    s_lshl_b32 s53, s53, 7
    s_lshl_b32 s52, s52, 7
    s_min_u32 s56, s52, s54
    s_mov_b32 s8, -8
    s_mov_b32 s55, 0
    s_min_u32 s77, s53, s49
    s_add_u32 s77, s77, 48396
    v_mov_b32 v20, s77
    s_mov_b32 s77, 0xffff7f
    s_cmp_lg_u32 s44, 7
    s_cbranch_scc1 K2_B9
    s_add_u32 s79, s49, 16
    v_lshl_add_u32 v16, v1, 2, s79
    v_and_b32 v17, 16, v16
    v_lshlrev_b32 v17, 3, v17
    s_lshl_b32 s79, s46, 8
    v_or_b32 v17, s79, v17
    v_mov_b32 v18, 0x7f0fffff
    ds_write2st64_b32 v16, v17, v18 offset0:156 offset1:189
K2_B9:
    s_waitcnt lgkmcnt(0)
    v_add_u32 v96, v96, v80
    v_add_u32 v97, v97, v81
    v_add_u32 v98, v98, v82
    v_add_u32 v99, v99, v83
    v_add_u32 v100, v100, v84
    v_add_u32 v101, v101, v85
    v_bfi_b32 v64, s77, v64, v96
    v_bfi_b32 v65, s77, v65, v97
    v_bfi_b32 v66, s77, v66, v98
    v_bfi_b32 v67, s77, v67, v99
    v_bfi_b32 v68, s77, v68, v100
    v_bfi_b32 v69, s77, v69, v101
    v_lshrrev_b32 v96, 3, v96
    v_lshrrev_b32 v97, 3, v97
    v_lshrrev_b32 v98, 3, v98
    v_lshrrev_b32 v99, 3, v99
    v_lshrrev_b32 v100, 3, v100
    v_lshrrev_b32 v101, 3, v101
    v_cmpx_lt_i32 vcc, 0, v22
    ds_write2st64_b32 v96, v64, v112 offset0:156 offset1:189
    v_cmpx_lt_i32 vcc, 4, v22
    ds_write2st64_b32 v97, v65, v113 offset0:156 offset1:189
    v_cmpx_lt_i32 vcc, 8, v22
    ds_write2st64_b32 v98, v66, v114 offset0:156 offset1:189
    v_cmpx_lt_i32 vcc, 12, v22
    ds_write2st64_b32 v99, v67, v115 offset0:156 offset1:189
    v_cmpx_lt_i32 vcc, 32, v22
    ds_write2st64_b32 v100, v68, v116 offset0:156 offset1:189
    v_cmpx_lt_i32 vcc, 36, v22
    ds_write2st64_b32 v101, v69, v117 offset0:156 offset1:189
    v_cmpx_lt_i32 vcc, 40, v22
    s_cbranch_execz K2_B10
    v_add_u32 v102, v102, v86
    v_add_u32 v103, v103, v87
    v_bfi_b32 v70, s77, v70, v102
    v_bfi_b32 v71, s77, v71, v103
    v_lshrrev_b32 v102, 3, v102
    v_lshrrev_b32 v103, 3, v103
    ds_write2st64_b32 v102, v70, v118 offset0:156 offset1:189
    v_cmpx_lt_i32 vcc, 44, v22
    ds_write2st64_b32 v103, v71, v119 offset0:156 offset1:189
    v_cmpx_lt_i32 vcc, 64, v22
    s_cbranch_execz K2_B10
    ds_read_b32 v104, v104 offset:36704
    v_add_u32 v120, 16, v23
    v_and_or_b32 v120, v72, s78, v120
    ds_read_b32 v105, v105 offset:36704
    v_add_u32 v121, 17, v23
    v_and_or_b32 v121, v73, s78, v121
    ds_read_b32 v106, v106 offset:36704
    v_add_u32 v122, 18, v23
    v_and_or_b32 v122, v74, s78, v122
    ds_read_b32 v107, v107 offset:36704
    v_add_u32 v123, 19, v23
    v_and_or_b32 v123, v75, s78, v123
    s_waitcnt lgkmcnt(0)
    v_add_u32 v104, v104, v88
    v_add_u32 v105, v105, v89
    v_add_u32 v106, v106, v90
    v_add_u32 v107, v107, v91
    v_bfi_b32 v72, s77, v72, v104
    v_bfi_b32 v73, s77, v73, v105
    v_bfi_b32 v74, s77, v74, v106
    v_bfi_b32 v75, s77, v75, v107
    v_lshrrev_b32 v104, 3, v104
    v_lshrrev_b32 v105, 3, v105
    v_lshrrev_b32 v106, 3, v106
    v_lshrrev_b32 v107, 3, v107
    ds_write2st64_b32 v104, v72, v120 offset0:156 offset1:189
    v_cmpx_lt_i32 vcc, 68, v22
    ds_write2st64_b32 v105, v73, v121 offset0:156 offset1:189
    v_cmpx_lt_i32 vcc, 72, v22
    ds_write2st64_b32 v106, v74, v122 offset0:156 offset1:189
    v_cmpx_lt_i32 vcc, 76, v22
    ds_write2st64_b32 v107, v75, v123 offset0:156 offset1:189
    v_cmpx_lt_i32 vcc, 96, v22
    s_cbranch_execz K2_B10
    ds_read_b32 v108, v108 offset:36704
    v_add_u32 v124, 24, v23
    v_and_or_b32 v124, v76, s78, v124
    ds_read_b32 v109, v109 offset:36704
    v_add_u32 v125, 25, v23
    v_and_or_b32 v125, v77, s78, v125
    ds_read_b32 v110, v110 offset:36704
    v_add_u32 v126, 26, v23
    v_and_or_b32 v126, v78, s78, v126
    ds_read_b32 v111, v111 offset:36704
    v_add_u32 v127, 27, v23
    v_and_or_b32 v127, v79, s78, v127
    s_waitcnt lgkmcnt(0)
    v_add_u32 v108, v108, v92
    v_add_u32 v109, v109, v93
    v_add_u32 v110, v110, v94
    v_add_u32 v111, v111, v95
    v_bfi_b32 v76, s77, v76, v108
    v_bfi_b32 v77, s77, v77, v109
    v_bfi_b32 v78, s77, v78, v110
    v_bfi_b32 v79, s77, v79, v111
    v_lshrrev_b32 v108, 3, v108
    v_lshrrev_b32 v109, 3, v109
    v_lshrrev_b32 v110, 3, v110
    v_lshrrev_b32 v111, 3, v111
    ds_write2st64_b32 v108, v76, v124 offset0:156 offset1:189
    v_cmpx_lt_i32 vcc, 100, v22
    ds_write2st64_b32 v109, v77, v125 offset0:156 offset1:189
    v_cmpx_lt_i32 vcc, 104, v22
    ds_write2st64_b32 v110, v78, v126 offset0:156 offset1:189
    v_cmpx_lt_i32 vcc, 108, v22
    ds_write2st64_b32 v111, v79, v127 offset0:156 offset1:189
K2_B10:
    s_mov_b64 exec, -1
    v_add_u32 v16, s56, v2
    v_add_u32 v17, s56, v3
    s_waitcnt vmcnt(0)
K2_B11:
    s_add_u32 s15, s15, 1
    v_cmp_ne_u32 vcc, s14, v24
    s_cmp_gt_u32 s15, 40000
    s_cbranch_scc1 K2_B12
    s_cbranch_vccz K2_B12
    s_mov_b64 exec, vcc
    global_load_dword v24, v14, s[24:25] sc1
    s_waitcnt vmcnt(0)
    s_branch K2_B11
K2_B12:
    s_mov_b64 exec, -1
    s_waitcnt lgkmcnt(0)
    s_barrier
    s_setprio 3
    ds_read2st64_b32 v[24:25], v16 offset0:156 offset1:189
    ds_read_b128 v[240:243], v17 offset:39952
    ds_read_b128 v[244:247], v17 offset:39984
    ds_read_b128 v[248:251], v17 offset:40016
    ds_read_b128 v[252:255], v17 offset:40048
    ds_read2_b32 v[20:21], v20 offset0:0 offset1:1
    s_waitcnt lgkmcnt(5)
    v_cndmask_b32 v12, v25, v24, s[64:65]
    v_bfe_u32 v12, v12, v15, 20
    buffer_load_dwordx3 v[32:34], v[12:13], s[60:63], 0 idxen offen sc1
    s_waitcnt lgkmcnt(0)
    buffer_load_dword v64, v240, s[28:31], 0 offen sc1
    buffer_load_dword v65, v241, s[28:31], 0 offen sc1
    buffer_load_dword v66, v242, s[28:31], 0 offen sc1
    buffer_load_dword v67, v243, s[28:31], 0 offen sc1
    buffer_load_dword v68, v244, s[28:31], 0 offen sc1
    buffer_load_dword v69, v245, s[28:31], 0 offen sc1
    buffer_load_dword v70, v246, s[28:31], 0 offen sc1
    buffer_load_dword v71, v247, s[28:31], 0 offen sc1
    buffer_load_dword v72, v248, s[28:31], 0 offen sc1
    buffer_load_dword v73, v249, s[28:31], 0 offen sc1
    buffer_load_dword v74, v250, s[28:31], 0 offen sc1
    buffer_load_dword v75, v251, s[28:31], 0 offen sc1
    buffer_load_dword v76, v252, s[28:31], 0 offen sc1
    buffer_load_dword v77, v253, s[28:31], 0 offen sc1
    buffer_load_dword v78, v254, s[28:31], 0 offen sc1
    buffer_load_dword v79, v255, s[28:31], 0 offen sc1
    v_readfirstlane_b32 s11, v20
    s_lshr_b32 s11, s11, 24
    v_readlane_b32 s78, v25, 0
    v_readlane_b32 s79, v25, 31
    s_add_u32 s77, s8, 8
    s_lshr_b32 s78, s78, 24
    s_lshr_b32 s79, s79, 24
    s_max_u32 s78, s78, s55
    s_min_u32 s59, s79, s11
    s_cmp_ge_i32 s59, s77
    s_cselect_b32 s58, s78, s8
    v_subrev_u32_sdwa v16, s58, v25 dst_sel:DWORD dst_unused:UNUSED_PAD src0_sel:DWORD src1_sel:BYTE_3
    v_lshlrev_b32_sdwa v22, 4, v25 dst_sel:DWORD dst_unused:UNUSED_PAD src0_sel:DWORD src1_sel:BYTE_3
    v_min_u32 v16, 8, v16
    v_lshl_add_u32 v23, v16, 4, v10
    v_lshl_add_u32 v14, v16, 3, v4
    s_cmp_lg_u32 s51, 1
    s_cbranch_scc1 K2_G8
    s_mov_b32 s51, 2
    ds_read_b128 v[160:163], v36 offset:0
    ds_read_b128 v[164:167], v37 offset:0
    ds_read_b128 v[168:171], v38 offset:0
    ds_read_b128 v[172:175], v39 offset:0
    ds_read_b128 v[176:179], v36 offset:4096
    ds_read_b128 v[180:183], v37 offset:4096
    ds_read_b128 v[184:187], v38 offset:4096
    ds_read_b128 v[188:191], v39 offset:4096
    ds_read_b128 v[224:227], v36 offset:8192
    ds_read_b128 v[228:231], v37 offset:8192
    ds_read_b128 v[232:235], v38 offset:8192
    ds_read_b128 v[236:239], v39 offset:8192
    ds_read_b128 v[96:99], v36 offset:12288
    ds_read_b128 v[100:103], v37 offset:12288
    ds_read_b128 v[104:107], v38 offset:12288
    ds_read_b128 v[108:111], v39 offset:12288
    s_waitcnt lgkmcnt(8)
    v_mfma_f32_16x16x32_bf16 v[192:195], v[144:147], v[160:163], 0
    ds_read_b128 v[160:163], v36 offset:16384
    v_mfma_f32_16x16x32_bf16 v[196:199], v[144:147], v[176:179], 0
    ds_read_b128 v[176:179], v36 offset:20480
    v_mfma_f32_16x16x32_bf16 v[192:195], v[148:151], v[164:167], v[192:195]
    ds_read_b128 v[164:167], v37 offset:16384
    v_mfma_f32_16x16x32_bf16 v[196:199], v[148:151], v[180:183], v[196:199]
    ds_read_b128 v[180:183], v37 offset:20480
    v_mfma_f32_16x16x32_bf16 v[192:195], v[152:155], v[168:171], v[192:195]
    ds_read_b128 v[168:171], v38 offset:16384
    v_mfma_f32_16x16x32_bf16 v[196:199], v[152:155], v[184:187], v[196:199]
    ds_read_b128 v[184:187], v38 offset:20480
    v_mfma_f32_16x16x32_bf16 v[192:195], v[156:159], v[172:175], v[192:195]
    ds_read_b128 v[172:175], v39 offset:16384
    v_mfma_f32_16x16x32_bf16 v[196:199], v[156:159], v[188:191], v[196:199]
    ds_read_b128 v[188:191], v39 offset:20480
    s_waitcnt lgkmcnt(8)
    v_mfma_f32_16x16x32_bf16 v[200:203], v[144:147], v[224:227], 0
    ds_read_b128 v[224:227], v36 offset:24576
    v_mfma_f32_16x16x32_bf16 v[204:207], v[144:147], v[96:99], 0
    v_mfma_f32_16x16x32_bf16 v[200:203], v[148:151], v[228:231], v[200:203]
    ds_read_b128 v[228:231], v37 offset:24576
    v_mfma_f32_16x16x32_bf16 v[204:207], v[148:151], v[100:103], v[204:207]
    v_mfma_f32_16x16x32_bf16 v[200:203], v[152:155], v[232:235], v[200:203]
    ds_read_b128 v[232:235], v38 offset:24576
    v_mfma_f32_16x16x32_bf16 v[204:207], v[152:155], v[104:107], v[204:207]
    v_mfma_f32_16x16x32_bf16 v[200:203], v[156:159], v[236:239], v[200:203]
    ds_read_b128 v[236:239], v39 offset:24576
    v_mfma_f32_16x16x32_bf16 v[204:207], v[156:159], v[108:111], v[204:207]
    s_waitcnt lgkmcnt(4)
    v_mfma_f32_16x16x32_bf16 v[208:211], v[144:147], v[160:163], 0
    v_mfma_f32_16x16x32_bf16 v[212:215], v[144:147], v[176:179], 0
    v_mfma_f32_16x16x32_bf16 v[208:211], v[148:151], v[164:167], v[208:211]
    v_mfma_f32_16x16x32_bf16 v[212:215], v[148:151], v[180:183], v[212:215]
    v_mfma_f32_16x16x32_bf16 v[208:211], v[152:155], v[168:171], v[208:211]
    v_mfma_f32_16x16x32_bf16 v[212:215], v[152:155], v[184:187], v[212:215]
    v_mfma_f32_16x16x32_bf16 v[208:211], v[156:159], v[172:175], v[208:211]
    v_mfma_f32_16x16x32_bf16 v[212:215], v[156:159], v[188:191], v[212:215]
    s_waitcnt lgkmcnt(0)
    v_mfma_f32_16x16x32_bf16 v[216:219], v[144:147], v[224:227], 0
    v_mfma_f32_16x16x32_bf16 v[216:219], v[148:151], v[228:231], v[216:219]
    v_mfma_f32_16x16x32_bf16 v[216:219], v[152:155], v[232:235], v[216:219]
    v_mfma_f32_16x16x32_bf16 v[216:219], v[156:159], v[236:239], v[216:219]
    v_pk_mul_f32 v[192:193], v[192:193], s[68:69]
    v_pk_mul_f32 v[194:195], v[194:195], s[68:69]
    v_pk_mul_f32 v[196:197], v[196:197], s[68:69]
    v_pk_mul_f32 v[198:199], v[198:199], s[68:69]
    v_pk_mul_f32 v[200:201], v[200:201], s[68:69]
    v_pk_mul_f32 v[202:203], v[202:203], s[68:69]
    v_pk_mul_f32 v[204:205], v[204:205], s[68:69]
    v_pk_mul_f32 v[206:207], v[206:207], s[68:69]
    v_pk_mul_f32 v[208:209], v[208:209], s[68:69]
    v_pk_mul_f32 v[210:211], v[210:211], s[68:69]
    v_pk_mul_f32 v[212:213], v[212:213], s[68:69]
    v_pk_mul_f32 v[214:215], v[214:215], s[68:69]
    v_pk_mul_f32 v[216:217], v[216:217], s[68:69]
    v_pk_mul_f32 v[218:219], v[218:219], s[68:69]
K2_G8:
    buffer_load_dword v80, v240, s[28:31], 0 offen offset:128 sc1
    buffer_load_dword v81, v241, s[28:31], 0 offen offset:128 sc1
    buffer_load_dword v82, v242, s[28:31], 0 offen offset:128 sc1
    buffer_load_dword v83, v243, s[28:31], 0 offen offset:128 sc1
    buffer_load_dword v84, v244, s[28:31], 0 offen offset:128 sc1
    buffer_load_dword v85, v245, s[28:31], 0 offen offset:128 sc1
    buffer_load_dword v86, v246, s[28:31], 0 offen offset:128 sc1
    buffer_load_dword v87, v247, s[28:31], 0 offen offset:128 sc1
    buffer_load_dword v88, v248, s[28:31], 0 offen offset:128 sc1
    buffer_load_dword v89, v249, s[28:31], 0 offen offset:128 sc1
    buffer_load_dword v90, v250, s[28:31], 0 offen offset:128 sc1
    buffer_load_dword v91, v251, s[28:31], 0 offen offset:128 sc1
    buffer_load_dword v92, v252, s[28:31], 0 offen offset:128 sc1
    buffer_load_dword v93, v253, s[28:31], 0 offen offset:128 sc1
    buffer_load_dword v94, v254, s[28:31], 0 offen offset:128 sc1
    buffer_load_dword v95, v255, s[28:31], 0 offen offset:128 sc1
K2_G9:
    v_mfma_f32_32x32x8_bf16 v[128:143], v[28:29], v[28:29], 0
    v_mfma_f32_32x32x8_bf16 v[144:159], v[28:29], v[28:29], 0
    v_mfma_f32_32x32x8_bf16 v[160:175], v[28:29], v[28:29], 0
    v_mfma_f32_32x32x8_bf16 v[176:191], v[28:29], v[28:29], 0
    s_cmp_lg_u32 s76, 0
    s_cbranch_scc1 K2_G10
    s_mov_b32 s8, 0
    s_mov_b32 s9, -1
    s_mov_b32 s11, -1
    s_waitcnt vmcnt(0)
    s_branch K2_TAIL
K2_G10:
    ds_read_b96 v[220:222], v22 offset:37216
    ds_read_b64 v[38:39], v23 offset:39424
    ds_read_b64_tr_b16 v[224:225], v6 offset:0
    ds_read_b64_tr_b16 v[228:229], v6 offset:64
    ds_read_b64_tr_b16 v[232:233], v6 offset:128
    ds_read_b64_tr_b16 v[236:237], v6 offset:192
    s_mul_i32 s77, s58, 264
    v_add_u32 v19, s77, v6
    ds_read_b64_tr_b16 v[226:227], v19 offset:2112
    ds_read_b64_tr_b16 v[230:231], v19 offset:2176
    ds_read_b64_tr_b16 v[234:235], v19 offset:2240
    ds_read_b64_tr_b16 v[238:239], v19 offset:2304
    s_add_u32 s77, s58, 8
    s_cmp_ge_i32 s59, s77
    s_cselect_b32 s55, s77, 0
    s_cselect_b32 s77, 0, 128
    s_add_u32 s52, s52, s77
    s_mov_b32 s57, s56
    s_cmp_lt_u32 s52, s53
    s_cselect_b32 s56, s52, s54
    v_add_u32 v16, s56, v2
    v_add_u32 v17, s56, v3
    ds_read2st64_b32 v[24:25], v16 offset0:156 offset1:189
    ds_read_b128 v[240:243], v17 offset:39952
    ds_read_b128 v[244:247], v17 offset:39984
    ds_read_b128 v[248:251], v17 offset:40016
    ds_read_b128 v[252:255], v17 offset:40048
    s_mov_b32 s8, s58
    s_mov_b32 s75, s76
    s_waitcnt vmcnt(16) lgkmcnt(0)
    v_pk_add_f32 v[16:17], v[220:221], v[32:33] neg_lo:[0,1] neg_hi:[0,1]
    v_sub_f32 v18, v222, v34
    v_cvt_pk_bf16_f32 v16, 1.0, v16
    v_cvt_pk_bf16_f32 v17, v17, v18
    v_dot2_f32_bf16 v19, v17, v17, 0
    v_and_b32 v18, 0xffff0000, v16
    v_mov_b32 v37, v33
    ds_write_b64 v14, v[16:17]
    v_fmac_f32 v19, v18, v18
    v_cvt_pk_bf16_f32 v19, v19, v19
    v_cndmask_b32 v36, v32, v19, s[64:65]
    v_cndmask_b32 v12, v25, v24, s[64:65]
    v_bfe_u32 v12, v12, v15, 20
    v_lshlrev_b64 v[112:113], 16, v[64:65]
    v_lshlrev_b64 v[114:115], 16, v[66:67]
    v_mfma_f32_32x32x16_bf16 v[96:111], v[36:39], v[224:227], v[64:79]
    v_lshlrev_b64 v[116:117], 16, v[68:69]
    v_lshlrev_b64 v[118:119], 16, v[70:71]
    v_lshlrev_b64 v[120:121], 16, v[72:73]
    v_lshlrev_b64 v[122:123], 16, v[74:75]
    v_lshlrev_b64 v[124:125], 16, v[76:77]
    v_lshlrev_b64 v[126:127], 16, v[78:79]
    s_setprio 2
    s_nop 0
    v_mfma_f32_32x32x16_bf16 v[112:127], v[36:39], v[228:231], v[112:127]
K2_LOOP:
    ds_read_b64_tr_b16 v[40:41], v5 offset:0
    ds_read_b64_tr_b16 v[42:43], v5 offset:576
    ds_read_b64_tr_b16 v[44:45], v5 offset:1152
    ds_read_b64_tr_b16 v[46:47], v5 offset:1728
    ds_write_b64 v14, v[28:29]
    buffer_load_dwordx3 v[32:34], v[12:13], s[60:63], 0 idxen offen sc1
    buffer_load_dword v64, v240, s[28:31], 0 offen sc1
    buffer_load_dword v65, v241, s[28:31], 0 offen sc1
    buffer_load_dword v66, v242, s[28:31], 0 offen sc1
    buffer_load_dword v67, v243, s[28:31], 0 offen sc1
    buffer_load_dword v68, v244, s[28:31], 0 offen sc1
    buffer_load_dword v69, v245, s[28:31], 0 offen sc1
    buffer_load_dword v70, v246, s[28:31], 0 offen sc1
    buffer_load_dword v71, v247, s[28:31], 0 offen sc1
    s_cmp_eq_u32 s58, s8
    s_cbranch_scc1 K2_L1
    s_mul_i32 s77, s8, 288
    s_sub_u32 s79, s9, s8
    s_lshl_b32 s78, s8, 5
    v_cmp_ge_i32 vcc, s79, v11
    v_add_u32 v20, s77, v8
    v_mov_b32 v16, 196608
    v_add_u32 v21, s78, v9
    v_cndmask_b32 v20, v16, v20, vcc
    v_cvt_pk_bf16_f32 v128, v128, v129
    v_cvt_pk_bf16_f32 v129, v130, v131
    v_cvt_pk_bf16_f32 v130, v132, v133
    v_cvt_pk_bf16_f32 v131, v134, v135
    v_cvt_pk_bf16_f32 v132, v136, v137
    v_cvt_pk_bf16_f32 v133, v138, v139
    v_cvt_pk_bf16_f32 v134, v140, v141
    v_cvt_pk_bf16_f32 v135, v142, v143
    ds_read_b128 v[136:139], v3 offset:39680
    ds_read_b128 v[140:143], v3 offset:39712
    ds_write2_b64 v20, v[128:129], v[130:131] offset0:0 offset1:2
    ds_write2_b64 v20, v[132:133], v[134:135] offset0:4 offset1:6
    v_cvt_pk_bf16_f32 v144, v144, v145
    v_cvt_pk_bf16_f32 v145, v146, v147
    v_cvt_pk_bf16_f32 v146, v148, v149
    v_cvt_pk_bf16_f32 v147, v150, v151
    v_cvt_pk_bf16_f32 v148, v152, v153
    v_cvt_pk_bf16_f32 v149, v154, v155
    v_cvt_pk_bf16_f32 v150, v156, v157
    v_cvt_pk_bf16_f32 v151, v158, v159
    ds_read_b128 v[152:155], v3 offset:39744
    ds_read_b128 v[156:159], v3 offset:39776
    ds_write2_b64 v20, v[144:145], v[146:147] offset0:8 offset1:10
    ds_write2_b64 v20, v[148:149], v[150:151] offset0:12 offset1:14
    v_cvt_pk_bf16_f32 v176, v176, v177
    v_cvt_pk_bf16_f32 v177, v178, v179
    v_cvt_pk_bf16_f32 v178, v180, v181
    v_cvt_pk_bf16_f32 v179, v182, v183
    v_cvt_pk_bf16_f32 v180, v184, v185
    v_cvt_pk_bf16_f32 v181, v186, v187
    v_cvt_pk_bf16_f32 v182, v188, v189
    v_cvt_pk_bf16_f32 v183, v190, v191
    ds_read_b128 v[184:187], v3 offset:39872
    ds_read_b128 v[188:191], v3 offset:39904
    ds_write2_b64 v20, v[176:177], v[178:179] offset0:24 offset1:26
    ds_write2_b64 v20, v[180:181], v[182:183] offset0:28 offset1:30
    v_cvt_pk_bf16_f32 v160, v160, v161
    v_cvt_pk_bf16_f32 v161, v162, v163
    v_cvt_pk_bf16_f32 v162, v164, v165
    v_cvt_pk_bf16_f32 v163, v166, v167
    v_cvt_pk_bf16_f32 v164, v168, v169
    v_cvt_pk_bf16_f32 v165, v170, v171
    v_cvt_pk_bf16_f32 v166, v172, v173
    v_cvt_pk_bf16_f32 v167, v174, v175
    ds_read_b128 v[168:171], v3 offset:39808
    ds_read_b128 v[172:175], v3 offset:39840
    ds_write2_b64 v20, v[160:161], v[162:163] offset0:16 offset1:18
    ds_write2_b64 v20, v[164:165], v[166:167] offset0:20 offset1:22
    s_mul_i32 s77, s58, 288
    s_sub_u32 s78, s11, s58
    v_add_u32 v30, s77, v7
    v_cmp_gt_i32 vcc, s78, v11
    ds_read_b64_tr_b16 v[48:49], v30 offset:0
    ds_read_b64_tr_b16 v[50:51], v30 offset:64
    ds_read_b64_tr_b16 v[52:53], v30 offset:128
    ds_read_b64_tr_b16 v[54:55], v30 offset:192
    v_cndmask_b32 v30, 0, v26, vcc
    v_cndmask_b32 v31, 0, v27, vcc
    s_waitcnt lgkmcnt(14)
    v_dot2_f32_bf16 v16, v128, v136, 0
    v_dot2_f32_bf16 v17, v144, v152, 0
    v_dot2_f32_bf16 v16, v129, v137, v16
    v_dot2_f32_bf16 v17, v145, v153, v17
    v_dot2_f32_bf16 v16, v130, v138, v16
    v_dot2_f32_bf16 v17, v146, v154, v17
    v_dot2_f32_bf16 v16, v131, v139, v16
    v_dot2_f32_bf16 v17, v147, v155, v17
    v_dot2_f32_bf16 v16, v132, v140, v16
    v_dot2_f32_bf16 v17, v148, v156, v17
    v_dot2_f32_bf16 v16, v133, v141, v16
    v_dot2_f32_bf16 v17, v149, v157, v17
    v_dot2_f32_bf16 v16, v134, v142, v16
    v_dot2_f32_bf16 v17, v150, v158, v17
    v_dot2_f32_bf16 v16, v135, v143, v16
    v_dot2_f32_bf16 v17, v151, v159, v17
    s_waitcnt lgkmcnt(6)
    v_dot2_f32_bf16 v16, v176, v184, v16
    v_dot2_f32_bf16 v17, v160, v168, v17
    v_dot2_f32_bf16 v16, v177, v185, v16
    v_dot2_f32_bf16 v17, v161, v169, v17
    v_dot2_f32_bf16 v16, v178, v186, v16
    v_dot2_f32_bf16 v17, v162, v170, v17
    v_dot2_f32_bf16 v16, v179, v187, v16
    v_dot2_f32_bf16 v17, v163, v171, v17
    v_dot2_f32_bf16 v16, v180, v188, v16
    v_dot2_f32_bf16 v17, v164, v172, v17
    v_dot2_f32_bf16 v16, v181, v189, v16
    v_dot2_f32_bf16 v17, v165, v173, v17
    v_dot2_f32_bf16 v16, v182, v190, v16
    v_dot2_f32_bf16 v17, v166, v174, v17
    v_dot2_f32_bf16 v16, v183, v191, v16
    v_dot2_f32_bf16 v17, v167, v175, v17
    s_waitcnt lgkmcnt(0)
    v_mfma_f32_32x32x8_bf16 v[144:159], v[50:51], v[30:31], 0
    v_mfma_f32_32x32x8_bf16 v[128:143], v[48:49], v[30:31], 0
    v_add_f32 v16, v16, v17
    v_cvt_f64_f32 v[18:19], v16
    v_mfma_f32_32x32x8_bf16 v[176:191], v[54:55], v[30:31], 0
    ds_add_f64 v21, v[18:19] offset:32768
    v_mfma_f32_32x32x8_bf16 v[160:175], v[52:53], v[30:31], 0
    s_mov_b32 s8, s58
    s_lshl_b32 s77, s44, 2
    v_mov_b32 v16, s77
    ds_write_b32 v16, v2 offset:36656
K2_L1:
    v_exp_f32 v48, v96
    buffer_load_dword v72, v248, s[28:31], 0 offen sc1
    buffer_load_dword v73, v249, s[28:31], 0 offen sc1
    buffer_load_dword v74, v250, s[28:31], 0 offen sc1
    buffer_load_dword v75, v251, s[28:31], 0 offen sc1
    buffer_load_dword v76, v252, s[28:31], 0 offen sc1
    buffer_load_dword v77, v253, s[28:31], 0 offen sc1
    buffer_load_dword v78, v254, s[28:31], 0 offen sc1
    buffer_load_dword v79, v255, s[28:31], 0 offen sc1
    v_exp_f32 v49, v97
    v_exp_f32 v50, v98
    v_exp_f32 v51, v99
    v_exp_f32 v52, v100
    v_exp_f32 v53, v101
    v_exp_f32 v54, v102
    v_exp_f32 v55, v103
    v_cvt_pk_bf16_f32 v56, v112, v113
    v_cvt_pk_bf16_f32 v57, v114, v115
    v_cvt_pk_bf16_f32 v58, v116, v117
    v_cvt_pk_bf16_f32 v59, v118, v119
    v_mul_lo_u16_sdwa v112, -2, v56 dst_sel:WORD_0 dst_unused:UNUSED_SEXT src0_sel:WORD_0 src1_sel:WORD_0
    v_mul_lo_u16_sdwa v113, -2, v57 dst_sel:WORD_0 dst_unused:UNUSED_SEXT src0_sel:WORD_0 src1_sel:WORD_0
    s_waitcnt lgkmcnt(1)
    v_mfma_f32_32x32x16_bf16 v[144:159], v[56:59], v[40:43], v[144:159]
    v_mul_lo_u16_sdwa v114, -2, v58 dst_sel:WORD_0 dst_unused:UNUSED_SEXT src0_sel:WORD_0 src1_sel:WORD_0
    v_mul_lo_u16_sdwa v115, -2, v59 dst_sel:WORD_0 dst_unused:UNUSED_SEXT src0_sel:WORD_0 src1_sel:WORD_0
    v_mul_lo_u16_sdwa v116, -2, v56 dst_sel:WORD_0 dst_unused:UNUSED_SEXT src0_sel:WORD_0 src1_sel:WORD_1
    v_mul_lo_u16_sdwa v117, -2, v57 dst_sel:WORD_0 dst_unused:UNUSED_SEXT src0_sel:WORD_0 src1_sel:WORD_1
    v_mul_lo_u16_sdwa v118, -2, v58 dst_sel:WORD_0 dst_unused:UNUSED_SEXT src0_sel:WORD_0 src1_sel:WORD_1
    v_mul_lo_u16_sdwa v119, -2, v59 dst_sel:WORD_0 dst_unused:UNUSED_SEXT src0_sel:WORD_0 src1_sel:WORD_1
    ds_read_u16 v112, v112
    ds_read_u16 v113, v113
    ds_read_u16 v114, v114
    ds_read_u16 v115, v115
    ds_read_u16_d16_hi v116, v116
    ds_read_u16_d16_hi v117, v117
    ds_read_u16_d16_hi v118, v118
    ds_read_u16_d16_hi v119, v119
    v_cvt_pk_bf16_f32 v60, v120, v121
    v_cvt_pk_bf16_f32 v61, v122, v123
    v_cvt_pk_bf16_f32 v62, v124, v125
    v_cvt_pk_bf16_f32 v63, v126, v127
    v_pk_add_f32 v[48:49], v[48:49], 1.0 op_sel_hi:[1,0]
    s_mov_b32 s9, s59
    v_pk_add_f32 v[50:51], v[50:51], 1.0 op_sel_hi:[1,0]
    v_pk_add_f32 v[52:53], v[52:53], 1.0 op_sel_hi:[1,0]
    v_readlane_b32 s78, v25, 0
    v_pk_add_f32 v[54:55], v[54:55], 1.0 op_sel_hi:[1,0]
    v_mfma_f32_32x32x16_bf16 v[144:159], v[60:63], v[44:47], v[144:159]
    v_rcp_f32 v48, v48
    v_rcp_f32 v49, v49
    v_rcp_f32 v50, v50
    v_rcp_f32 v51, v51
    v_rcp_f32 v52, v52
    v_rcp_f32 v53, v53
    v_readlane_b32 s79, v25, 31
    v_rcp_f32 v54, v54
    v_rcp_f32 v55, v55
    v_mul_lo_u16_sdwa v120, -2, v60 dst_sel:WORD_0 dst_unused:UNUSED_SEXT src0_sel:WORD_0 src1_sel:WORD_0
    s_add_u32 s77, s8, 8
    v_mul_lo_u16_sdwa v121, -2, v61 dst_sel:WORD_0 dst_unused:UNUSED_SEXT src0_sel:WORD_0 src1_sel:WORD_0
    v_mul_lo_u16_sdwa v122, -2, v62 dst_sel:WORD_0 dst_unused:UNUSED_SEXT src0_sel:WORD_0 src1_sel:WORD_0
    v_mul_lo_u16_sdwa v123, -2, v63 dst_sel:WORD_0 dst_unused:UNUSED_SEXT src0_sel:WORD_0 src1_sel:WORD_0
    s_lshr_b32 s78, s78, 24
    v_mul_lo_u16_sdwa v124, -2, v60 dst_sel:WORD_0 dst_unused:UNUSED_SEXT src0_sel:WORD_0 src1_sel:WORD_1
    v_mul_lo_u16_sdwa v125, -2, v61 dst_sel:WORD_0 dst_unused:UNUSED_SEXT src0_sel:WORD_0 src1_sel:WORD_1
    v_mul_lo_u16_sdwa v126, -2, v62 dst_sel:WORD_0 dst_unused:UNUSED_SEXT src0_sel:WORD_0 src1_sel:WORD_1
    s_lshr_b32 s79, s79, 24
    v_mul_lo_u16_sdwa v127, -2, v63 dst_sel:WORD_0 dst_unused:UNUSED_SEXT src0_sel:WORD_0 src1_sel:WORD_1
    ds_read_u16 v120, v120
    s_max_u32 s78, s78, s55
    ds_read_u16 v121, v121
    ds_read_u16 v122, v122
    ds_read_u16 v123, v123
    s_min_u32 s59, s79, s11
    ds_read_u16_d16_hi v124, v124
    ds_read_u16_d16_hi v125, v125
    ds_read_u16_d16_hi v126, v126
    s_cmp_ge_i32 s59, s77
    ds_read_u16_d16_hi v127, v127
    v_pk_mul_f32 v[48:49], v[96:97], v[48:49]
    v_pk_mul_f32 v[50:51], v[98:99], v[50:51]
    s_cselect_b32 s58, s78, s8
    v_pk_mul_f32 v[52:53], v[100:101], v[52:53]
    v_pk_mul_f32 v[54:55], v[102:103], v[54:55]
    s_setprio 0
    s_cmp_lt_u32 s44, 4
    s_cbranch_scc1 K2_Y0
    s_setprio 1
K2_Y0:
    s_add_u32 s77, s58, 8
    s_waitcnt lgkmcnt(8)
    v_or_b32 v112, v112, v116
    v_or_b32 v113, v113, v117
    s_cmp_ge_i32 s59, s77
    v_or_b32 v114, v114, v118
    v_or_b32 v115, v115, v119
    v_cvt_pk_bf16_f32 v56, v48, v49
    s_cselect_b32 s55, s77, 0
    v_cvt_pk_bf16_f32 v57, v50, v51
    v_mfma_f32_32x32x16_bf16 v[144:159], v[112:115], v[40:43], v[144:159]
    v_cvt_pk_bf16_f32 v58, v52, v53
    v_cvt_pk_bf16_f32 v59, v54, v55
    v_exp_f32 v48, v104
    v_exp_f32 v49, v105
    v_mfma_f32_32x32x16_bf16 v[128:143], v[56:59], v[40:43], v[128:143]
    v_exp_f32 v50, v106
    v_exp_f32 v51, v107
    v_exp_f32 v52, v108
    v_exp_f32 v53, v109
    v_exp_f32 v54, v110
    s_cselect_b32 s77, 0, 128
    v_exp_f32 v55, v111
    v_pk_add_f32 v[48:49], v[48:49], 1.0 op_sel_hi:[1,0]
    v_pk_add_f32 v[50:51], v[50:51], 1.0 op_sel_hi:[1,0]
    s_add_u32 s52, s52, s77
    v_pk_add_f32 v[52:53], v[52:53], 1.0 op_sel_hi:[1,0]
    v_pk_add_f32 v[54:55], v[54:55], 1.0 op_sel_hi:[1,0]
    s_waitcnt lgkmcnt(0)
    v_or_b32 v120, v120, v124
    s_mov_b32 s57, s56
    v_or_b32 v121, v121, v125
    v_or_b32 v122, v122, v126
    v_or_b32 v123, v123, v127
    v_rcp_f32 v48, v48
    s_cmp_lt_u32 s52, s53
    v_rcp_f32 v49, v49
    v_mfma_f32_32x32x16_bf16 v[144:159], v[120:123], v[44:47], v[144:159]
    v_rcp_f32 v50, v50
    v_rcp_f32 v51, v51
    v_rcp_f32 v52, v52
    v_rcp_f32 v53, v53
    v_rcp_f32 v54, v54
    v_rcp_f32 v55, v55
    v_pk_mul_f32 v[48:49], v[104:105], v[48:49]
    s_cselect_b32 s56, s52, s54
    v_pk_mul_f32 v[50:51], v[106:107], v[50:51]
    v_pk_mul_f32 v[52:53], v[108:109], v[52:53]
    v_pk_mul_f32 v[54:55], v[110:111], v[54:55]
    v_subrev_u32_sdwa v16, s58, v25 dst_sel:DWORD dst_unused:UNUSED_PAD src0_sel:DWORD src1_sel:BYTE_3
    v_lshlrev_b32_sdwa v22, 4, v25 dst_sel:DWORD dst_unused:UNUSED_PAD src0_sel:DWORD src1_sel:BYTE_3
    v_min_u32 v16, 8, v16
    s_waitcnt vmcnt(17)
    s_setprio 2
    v_mfma_f32_32x32x16_bf16 v[96:111], v[36:39], v[232:235], v[80:95]
    v_cvt_pk_bf16_f32 v60, v48, v49
    v_cvt_pk_bf16_f32 v61, v50, v51
    v_cvt_pk_bf16_f32 v62, v52, v53
    v_cvt_pk_bf16_f32 v63, v54, v55
    v_lshlrev_b64 v[112:113], 16, v[80:81]
    v_lshlrev_b64 v[114:115], 16, v[82:83]
    v_mfma_f32_32x32x16_bf16 v[128:143], v[60:63], v[44:47], v[128:143]
    v_lshlrev_b64 v[116:117], 16, v[84:85]
    v_lshlrev_b64 v[118:119], 16, v[86:87]
    v_lshlrev_b64 v[120:121], 16, v[88:89]
    v_lshlrev_b64 v[122:123], 16, v[90:91]
    v_lshlrev_b64 v[124:125], 16, v[92:93]
    v_lshlrev_b64 v[126:127], 16, v[94:95]
    v_lshl_add_u32 v23, v16, 4, v10
    v_lshl_add_u32 v14, v16, 3, v4
    v_mfma_f32_32x32x16_bf16 v[112:127], v[36:39], v[236:239], v[112:127]
    buffer_load_dword v80, v240, s[28:31], 0 offen offset:128 sc1
    buffer_load_dword v81, v241, s[28:31], 0 offen offset:128 sc1
    buffer_load_dword v82, v242, s[28:31], 0 offen offset:128 sc1
    buffer_load_dword v83, v243, s[28:31], 0 offen offset:128 sc1
    buffer_load_dword v84, v244, s[28:31], 0 offen offset:128 sc1
    buffer_load_dword v85, v245, s[28:31], 0 offen offset:128 sc1
    buffer_load_dword v86, v246, s[28:31], 0 offen offset:128 sc1
    buffer_load_dword v87, v247, s[28:31], 0 offen offset:128 sc1
    s_cmp_eq_u32 s58, s8
    s_cbranch_scc1 K2_L2
    s_mul_i32 s77, s58, 264
    v_add_u32 v19, s77, v6
    ds_read_b64_tr_b16 v[226:227], v19 offset:2112
    ds_read_b64_tr_b16 v[230:231], v19 offset:2176
    ds_read_b64_tr_b16 v[234:235], v19 offset:2240
    ds_read_b64_tr_b16 v[238:239], v19 offset:2304
K2_L2:
    ds_read_b96 v[220:222], v22 offset:37216
    ds_read_b64 v[38:39], v23 offset:39424
    v_exp_f32 v48, v96
    buffer_load_dword v88, v248, s[28:31], 0 offen offset:128 sc1
    buffer_load_dword v89, v249, s[28:31], 0 offen offset:128 sc1
    buffer_load_dword v90, v250, s[28:31], 0 offen offset:128 sc1
    buffer_load_dword v91, v251, s[28:31], 0 offen offset:128 sc1
    buffer_load_dword v92, v252, s[28:31], 0 offen offset:128 sc1
    buffer_load_dword v93, v253, s[28:31], 0 offen offset:128 sc1
    buffer_load_dword v94, v254, s[28:31], 0 offen offset:128 sc1
    buffer_load_dword v95, v255, s[28:31], 0 offen offset:128 sc1
    v_exp_f32 v49, v97
    v_exp_f32 v50, v98
    v_exp_f32 v51, v99
    v_exp_f32 v52, v100
    v_exp_f32 v53, v101
    v_exp_f32 v54, v102
    v_exp_f32 v55, v103
    v_cvt_pk_bf16_f32 v56, v112, v113
    v_cvt_pk_bf16_f32 v57, v114, v115
    v_cvt_pk_bf16_f32 v58, v116, v117
    v_cvt_pk_bf16_f32 v59, v118, v119
    v_mul_lo_u16_sdwa v112, -2, v56 dst_sel:WORD_0 dst_unused:UNUSED_SEXT src0_sel:WORD_0 src1_sel:WORD_0
    v_mul_lo_u16_sdwa v113, -2, v57 dst_sel:WORD_0 dst_unused:UNUSED_SEXT src0_sel:WORD_0 src1_sel:WORD_0
    v_mfma_f32_32x32x16_bf16 v[176:191], v[56:59], v[40:43], v[176:191]
    v_mul_lo_u16_sdwa v114, -2, v58 dst_sel:WORD_0 dst_unused:UNUSED_SEXT src0_sel:WORD_0 src1_sel:WORD_0
    v_mul_lo_u16_sdwa v115, -2, v59 dst_sel:WORD_0 dst_unused:UNUSED_SEXT src0_sel:WORD_0 src1_sel:WORD_0
    v_mul_lo_u16_sdwa v116, -2, v56 dst_sel:WORD_0 dst_unused:UNUSED_SEXT src0_sel:WORD_0 src1_sel:WORD_1
    v_mul_lo_u16_sdwa v117, -2, v57 dst_sel:WORD_0 dst_unused:UNUSED_SEXT src0_sel:WORD_0 src1_sel:WORD_1
    v_mul_lo_u16_sdwa v118, -2, v58 dst_sel:WORD_0 dst_unused:UNUSED_SEXT src0_sel:WORD_0 src1_sel:WORD_1
    v_mul_lo_u16_sdwa v119, -2, v59 dst_sel:WORD_0 dst_unused:UNUSED_SEXT src0_sel:WORD_0 src1_sel:WORD_1
    ds_read_u16 v112, v112
    ds_read_u16 v113, v113
    ds_read_u16 v114, v114
    ds_read_u16 v115, v115
    ds_read_u16_d16_hi v116, v116
    ds_read_u16_d16_hi v117, v117
    ds_read_u16_d16_hi v118, v118
    ds_read_u16_d16_hi v119, v119
    v_cvt_pk_bf16_f32 v60, v120, v121
    v_cvt_pk_bf16_f32 v61, v122, v123
    v_cvt_pk_bf16_f32 v62, v124, v125
    v_cvt_pk_bf16_f32 v63, v126, v127
    v_pk_add_f32 v[48:49], v[48:49], 1.0 op_sel_hi:[1,0]
    v_add_u32 v16, s56, v2
    v_add_u32 v17, s56, v3
    ds_read2st64_b32 v[24:25], v16 offset0:156 offset1:189
    ds_read_b128 v[240:243], v17 offset:39952
    ds_read_b128 v[244:247], v17 offset:39984
    ds_read_b128 v[248:251], v17 offset:40016
    ds_read_b128 v[252:255], v17 offset:40048
    v_pk_add_f32 v[50:51], v[50:51], 1.0 op_sel_hi:[1,0]
    v_pk_add_f32 v[52:53], v[52:53], 1.0 op_sel_hi:[1,0]
    v_pk_add_f32 v[54:55], v[54:55], 1.0 op_sel_hi:[1,0]
    v_mfma_f32_32x32x16_bf16 v[176:191], v[60:63], v[44:47], v[176:191]
    v_rcp_f32 v48, v48
    v_rcp_f32 v49, v49
    v_rcp_f32 v50, v50
    v_rcp_f32 v51, v51
    v_rcp_f32 v52, v52
    v_rcp_f32 v53, v53
    v_rcp_f32 v54, v54
    v_rcp_f32 v55, v55
    v_mul_lo_u16_sdwa v120, -2, v60 dst_sel:WORD_0 dst_unused:UNUSED_SEXT src0_sel:WORD_0 src1_sel:WORD_0
    v_mul_lo_u16_sdwa v121, -2, v61 dst_sel:WORD_0 dst_unused:UNUSED_SEXT src0_sel:WORD_0 src1_sel:WORD_0
    v_mul_lo_u16_sdwa v122, -2, v62 dst_sel:WORD_0 dst_unused:UNUSED_SEXT src0_sel:WORD_0 src1_sel:WORD_0
    v_mul_lo_u16_sdwa v123, -2, v63 dst_sel:WORD_0 dst_unused:UNUSED_SEXT src0_sel:WORD_0 src1_sel:WORD_0
    v_mul_lo_u16_sdwa v124, -2, v60 dst_sel:WORD_0 dst_unused:UNUSED_SEXT src0_sel:WORD_0 src1_sel:WORD_1
    v_mul_lo_u16_sdwa v125, -2, v61 dst_sel:WORD_0 dst_unused:UNUSED_SEXT src0_sel:WORD_0 src1_sel:WORD_1
    v_mul_lo_u16_sdwa v126, -2, v62 dst_sel:WORD_0 dst_unused:UNUSED_SEXT src0_sel:WORD_0 src1_sel:WORD_1
    v_mul_lo_u16_sdwa v127, -2, v63 dst_sel:WORD_0 dst_unused:UNUSED_SEXT src0_sel:WORD_0 src1_sel:WORD_1
    ds_read_u16 v120, v120
    ds_read_u16 v121, v121
    ds_read_u16 v122, v122
    ds_read_u16 v123, v123
    ds_read_u16_d16_hi v124, v124
    ds_read_u16_d16_hi v125, v125
    ds_read_u16_d16_hi v126, v126
    ds_read_u16_d16_hi v127, v127
    v_pk_mul_f32 v[48:49], v[96:97], v[48:49]
    v_pk_mul_f32 v[50:51], v[98:99], v[50:51]
    v_pk_mul_f32 v[52:53], v[100:101], v[52:53]
    v_pk_mul_f32 v[54:55], v[102:103], v[54:55]
    s_setprio 0
    s_cmp_lt_u32 s44, s10
    s_cbranch_scc1 K2_Y1
    s_setprio 1
K2_Y1:
    s_waitcnt lgkmcnt(13)
    v_or_b32 v112, v112, v116
    v_or_b32 v113, v113, v117
    v_or_b32 v114, v114, v118
    v_or_b32 v115, v115, v119
    v_cvt_pk_bf16_f32 v56, v48, v49
    v_cvt_pk_bf16_f32 v57, v50, v51
    v_mfma_f32_32x32x16_bf16 v[176:191], v[112:115], v[40:43], v[176:191]
    v_cvt_pk_bf16_f32 v58, v52, v53
    v_cvt_pk_bf16_f32 v59, v54, v55
    v_exp_f32 v48, v104
    v_exp_f32 v49, v105
    v_mfma_f32_32x32x16_bf16 v[160:175], v[56:59], v[40:43], v[160:175]
    v_exp_f32 v50, v106
    v_exp_f32 v51, v107
    v_exp_f32 v52, v108
    v_exp_f32 v53, v109
    v_exp_f32 v54, v110
    v_exp_f32 v55, v111
    v_pk_add_f32 v[48:49], v[48:49], 1.0 op_sel_hi:[1,0]
    v_pk_add_f32 v[50:51], v[50:51], 1.0 op_sel_hi:[1,0]
    v_pk_add_f32 v[52:53], v[52:53], 1.0 op_sel_hi:[1,0]
    v_pk_add_f32 v[54:55], v[54:55], 1.0 op_sel_hi:[1,0]
    s_waitcnt lgkmcnt(0)
    v_or_b32 v120, v120, v124
    v_or_b32 v121, v121, v125
    v_or_b32 v122, v122, v126
    v_or_b32 v123, v123, v127
    v_rcp_f32 v48, v48
    v_rcp_f32 v49, v49
    v_mfma_f32_32x32x16_bf16 v[176:191], v[120:123], v[44:47], v[176:191]
    v_rcp_f32 v50, v50
    v_rcp_f32 v51, v51
    v_rcp_f32 v52, v52
    v_rcp_f32 v53, v53
    v_rcp_f32 v54, v54
    v_rcp_f32 v55, v55
    v_pk_mul_f32 v[48:49], v[104:105], v[48:49]
    v_pk_mul_f32 v[50:51], v[106:107], v[50:51]
    v_pk_mul_f32 v[52:53], v[108:109], v[52:53]
    v_pk_mul_f32 v[54:55], v[110:111], v[54:55]
    s_waitcnt vmcnt(16)
    s_waitcnt lgkmcnt(8)
    v_pk_add_f32 v[16:17], v[220:221], v[32:33] neg_lo:[0,1] neg_hi:[0,1]
    v_sub_f32 v18, v222, v34
    v_cvt_pk_bf16_f32 v16, 1.0, v16
    v_cvt_pk_bf16_f32 v17, v17, v18
    v_dot2_f32_bf16 v19, v17, v17, 0
    v_and_b32 v18, 0xffff0000, v16
    v_mov_b32 v37, v33
    ds_write_b64 v14, v[16:17]
    v_fmac_f32 v19, v18, v18
    v_cvt_pk_bf16_f32 v19, v19, v19
    v_cndmask_b32 v36, v32, v19, s[64:65]
    v_cndmask_b32 v12, v25, v24, s[64:65]
    s_setprio 2
    v_mfma_f32_32x32x16_bf16 v[96:111], v[36:39], v[224:227], v[64:79]
    v_cvt_pk_bf16_f32 v60, v48, v49
    v_cvt_pk_bf16_f32 v61, v50, v51
    v_cvt_pk_bf16_f32 v62, v52, v53
    v_cvt_pk_bf16_f32 v63, v54, v55
    v_lshlrev_b64 v[112:113], 16, v[64:65]
    v_lshlrev_b64 v[114:115], 16, v[66:67]
    v_mfma_f32_32x32x16_bf16 v[160:175], v[60:63], v[44:47], v[160:175]
    v_lshlrev_b64 v[116:117], 16, v[68:69]
    v_lshlrev_b64 v[118:119], 16, v[70:71]
    v_lshlrev_b64 v[120:121], 16, v[72:73]
    v_lshlrev_b64 v[122:123], 16, v[74:75]
    v_lshlrev_b64 v[124:125], 16, v[76:77]
    v_lshlrev_b64 v[126:127], 16, v[78:79]
    v_bfe_u32 v12, v12, v15, 20
    s_cmp_lg_u32 s57, s54
    v_mfma_f32_32x32x16_bf16 v[112:127], v[36:39], v[228:231], v[112:127]
    s_cbranch_scc1 K2_LOOP
K2_TAIL:
    s_setprio 3
    s_lshl_b32 s3, s44, 2
    v_mov_b32 v32, s3
    s_cmp_eq_u32 s44, 7
    s_cselect_b32 s26, 1, 0
K2_W1:
    ds_read_b32 v33, v32 offset:36660
    s_mul_i32 s77, s8, 288
    s_sub_u32 s78, s11, s8
    v_add_u32 v30, s77, v7
    v_cmp_eq_i32 vcc, s78, v11
    ds_read_b64_tr_b16 v[48:49], v30 offset:0
    ds_read_b64_tr_b16 v[50:51], v30 offset:64
    ds_read_b64_tr_b16 v[52:53], v30 offset:128
    ds_read_b64_tr_b16 v[54:55], v30 offset:192
    v_cndmask_b32 v30, 0, v26, vcc
    v_cndmask_b32 v31, 0, v27, vcc
    s_mul_i32 s77, s8, 288
    s_sub_u32 s79, s9, s8
    s_lshl_b32 s78, s8, 5
    v_cmp_ge_i32 vcc, s79, v11
    v_add_u32 v20, s77, v8
    v_mov_b32 v16, 196608
    v_add_u32 v21, s78, v9
    v_cndmask_b32 v20, v16, v20, vcc
    s_waitcnt lgkmcnt(0)
    v_readfirstlane_b32 s77, v33
    s_or_b32 s77, s77, s26
    s_cbranch_scc0 K2_W1
K2_W2:
    v_mfma_f32_32x32x8_bf16 v[128:143], v[48:49], v[30:31], v[128:143]
    v_and_b32 v16, 15, v1
    v_lshrrev_b32 v17, 4, v1
    v_mul_u32_u24 v36, 288, v16
    v_lshl_add_u32 v36, v17, 4, v36
    v_add_u32 v36, 56848, v36
    s_lshl_b32 s77, s44, 1
    v_lshrrev_b32 v18, 1, v17
    v_mfma_f32_32x32x8_bf16 v[144:159], v[50:51], v[30:31], v[144:159]
    v_add_u32 v18, s77, v18
    v_xor_b32 v18, v18, v16
    v_lshlrev_b32 v18, 4, v18
    v_lshl_add_u32 v18, v16, 8, v18
    v_and_b32 v19, 1, v17
    v_lshl_add_u32 v18, v19, 3, v18
    v_add_u32 v37, 135936, v18
    v_mfma_f32_32x32x8_bf16 v[160:175], v[52:53], v[30:31], v[160:175]
    v_cvt_pk_bf16_f32 v128, v128, v129
    v_cvt_pk_bf16_f32 v129, v130, v131
    v_cvt_pk_bf16_f32 v130, v132, v133
    v_cvt_pk_bf16_f32 v131, v134, v135
    v_cvt_pk_bf16_f32 v132, v136, v137
    v_cvt_pk_bf16_f32 v133, v138, v139
    v_cvt_pk_bf16_f32 v134, v140, v141
    v_cvt_pk_bf16_f32 v135, v142, v143
    ds_write2_b64 v20, v[128:129], v[130:131] offset0:0 offset1:2
    ds_write2_b64 v20, v[132:133], v[134:135] offset0:4 offset1:6
    v_mfma_f32_32x32x8_bf16 v[176:191], v[54:55], v[30:31], v[176:191]
    v_cvt_pk_bf16_f32 v144, v144, v145
    v_cvt_pk_bf16_f32 v145, v146, v147
    v_cvt_pk_bf16_f32 v146, v148, v149
    v_cvt_pk_bf16_f32 v147, v150, v151
    v_cvt_pk_bf16_f32 v148, v152, v153
    v_cvt_pk_bf16_f32 v149, v154, v155
    v_cvt_pk_bf16_f32 v150, v156, v157
    v_cvt_pk_bf16_f32 v151, v158, v159
    ds_write2_b64 v20, v[144:145], v[146:147] offset0:8 offset1:10
    ds_write2_b64 v20, v[148:149], v[150:151] offset0:12 offset1:14
    v_cvt_pk_bf16_f32 v160, v160, v161
    v_cvt_pk_bf16_f32 v161, v162, v163
    v_cvt_pk_bf16_f32 v162, v164, v165
    v_cvt_pk_bf16_f32 v163, v166, v167
    v_cvt_pk_bf16_f32 v164, v168, v169
    v_cvt_pk_bf16_f32 v165, v170, v171
    v_cvt_pk_bf16_f32 v166, v172, v173
    v_cvt_pk_bf16_f32 v167, v174, v175
    ds_write2_b64 v20, v[160:161], v[162:163] offset0:16 offset1:18
    ds_write2_b64 v20, v[164:165], v[166:167] offset0:20 offset1:22
    s_nop 0
    v_cvt_pk_bf16_f32 v176, v176, v177
    v_cvt_pk_bf16_f32 v177, v178, v179
    v_cvt_pk_bf16_f32 v178, v180, v181
    v_cvt_pk_bf16_f32 v179, v182, v183
    v_cvt_pk_bf16_f32 v180, v184, v185
    v_cvt_pk_bf16_f32 v181, v186, v187
    v_cvt_pk_bf16_f32 v182, v188, v189
    v_cvt_pk_bf16_f32 v183, v190, v191
    ds_write2_b64 v20, v[176:177], v[178:179] offset0:24 offset1:26
    ds_write2_b64 v20, v[180:181], v[182:183] offset0:28 offset1:30
    v_mov_b32 v33, 1
    s_mov_b64 exec, 1
    ds_write_b32 v32, v33 offset:36656
    ds_add_u32 v28, v33 offset:36644
    s_mov_b64 exec, -1
    s_lshl_b32 s77, s44, 12
    s_add_u32 s77, s77, 7176192
    v_lshl_add_u32 v38, v1, 4, s77
    global_load_dwordx4 v[240:243], v38, s[24:25] offset:0 sc1
    global_load_dwordx4 v[244:247], v38, s[24:25] offset:1024 sc1
    global_load_dwordx4 v[248:251], v38, s[24:25] offset:2048 sc1
    global_load_dwordx4 v[252:255], v38, s[24:25] offset:3072 sc1
    ds_read_b64 v[224:225], v37 offset:0
    ds_read_b64 v[226:227], v37 offset:4096
    ds_read_b64 v[228:229], v37 offset:8192
    ds_read_b64 v[230:231], v37 offset:12288
    ds_read_b64 v[232:233], v37 offset:16384
    ds_read_b64 v[234:235], v37 offset:20480
    ds_read_b64 v[236:237], v37 offset:24576
    ds_read_b128 v[136:139], v3 offset:39680
    ds_read_b128 v[140:143], v3 offset:39712
    ds_read_b128 v[152:155], v3 offset:39744
    ds_read_b128 v[156:159], v3 offset:39776
    ds_read_b128 v[168:171], v3 offset:39808
    ds_read_b128 v[172:175], v3 offset:39840
    ds_read_b128 v[184:187], v3 offset:39872
    ds_read_b128 v[188:191], v3 offset:39904
    s_mul_i32 s78, s46, 6
    v_lshl_add_u32 v45, v0, 1, s78
    v_mul_u32_u24 v18, 171, v0
    v_lshrrev_b32 v18, 9, v18
    v_add_lshl_u32 v46, v18, v0, 2
    v_lshlrev_b32 v47, 1, v46
    v_cmp_gt_u32 vcc, 294, v0
    v_mov_b32 v18, 150000
    v_and_b32 v16, 15, v1
    v_cndmask_b32 v45, v18, v45, vcc
    v_lshrrev_b32 v17, 4, v1
    v_xor_b32 v18, v16, v17
    v_lshlrev_b32 v18, 4, v18
    v_lshl_add_u32 v18, v17, 8, v18
    s_lshl_b32 s77, s44, 12
    s_lshl_b32 s78, s46, 8
    s_add_u32 s78, s78, s77
    v_add_u32 v40, s78, v18
    v_xor_b32 v41, 64, v40
    v_xor_b32 v42, 128, v40
    v_xor_b32 v43, 192, v40
    v_lshl_add_u32 v44, v1, 4, s77
    v_subrev_u32 v37, 135936, v37
    s_mov_b32 s36, s20
    s_mov_b32 s37, s21
    s_mov_b32 s38, s34
    s_add_u32 s16, s20, 6400000
    s_addc_u32 s17, s21, 0
    s_mov_b32 s18, 150000
    s_mov_b32 s19, 0x20000
    v_min_u32 v32, 1, v1
    v_lshlrev_b32 v32, 17, v32
    v_mov_b32 v34, 1
    s_waitcnt vmcnt(4) lgkmcnt(0)
    v_lshlrev_b32 v64, 16, v224
    v_and_b32 v65, 0xffff0000, v224
    v_lshlrev_b32 v66, 16, v225
    v_and_b32 v67, 0xffff0000, v225
    v_lshlrev_b32 v68, 16, v226
    v_and_b32 v69, 0xffff0000, v226
    v_lshlrev_b32 v70, 16, v227
    v_and_b32 v71, 0xffff0000, v227
    v_lshlrev_b32 v72, 16, v228
    v_and_b32 v73, 0xffff0000, v228
    v_lshlrev_b32 v74, 16, v229
    v_and_b32 v75, 0xffff0000, v229
    v_lshlrev_b32 v76, 16, v230
    v_and_b32 v77, 0xffff0000, v230
    v_lshlrev_b32 v78, 16, v231
    v_and_b32 v79, 0xffff0000, v231
    v_lshlrev_b32 v80, 16, v232
    v_and_b32 v81, 0xffff0000, v232
    v_lshlrev_b32 v82, 16, v233
    v_and_b32 v83, 0xffff0000, v233
    v_lshlrev_b32 v84, 16, v234
    v_and_b32 v85, 0xffff0000, v234
    v_lshlrev_b32 v86, 16, v235
    v_and_b32 v87, 0xffff0000, v235
    v_lshlrev_b32 v88, 16, v236
    v_and_b32 v89, 0xffff0000, v236
    v_lshlrev_b32 v90, 16, v237
    v_and_b32 v91, 0xffff0000, v237
    v_dot2_f32_bf16 v16, v128, v136, 0
    v_dot2_f32_bf16 v17, v144, v152, 0
    v_dot2_f32_bf16 v16, v129, v137, v16
    v_dot2_f32_bf16 v17, v145, v153, v17
    v_dot2_f32_bf16 v16, v130, v138, v16
    v_dot2_f32_bf16 v17, v146, v154, v17
    v_dot2_f32_bf16 v16, v131, v139, v16
    v_dot2_f32_bf16 v17, v147, v155, v17
    v_dot2_f32_bf16 v16, v132, v140, v16
    v_dot2_f32_bf16 v17, v148, v156, v17
    v_dot2_f32_bf16 v16, v133, v141, v16
    v_dot2_f32_bf16 v17, v149, v157, v17
    v_dot2_f32_bf16 v16, v134, v142, v16
    v_dot2_f32_bf16 v17, v150, v158, v17
    v_dot2_f32_bf16 v16, v135, v143, v16
    v_dot2_f32_bf16 v17, v151, v159, v17
    v_dot2_f32_bf16 v16, v176, v184, v16
    v_dot2_f32_bf16 v17, v160, v168, v17
    v_dot2_f32_bf16 v16, v177, v185, v16
    v_dot2_f32_bf16 v17, v161, v169, v17
    v_dot2_f32_bf16 v16, v178, v186, v16
    v_dot2_f32_bf16 v17, v162, v170, v17
    v_dot2_f32_bf16 v16, v179, v187, v16
    v_dot2_f32_bf16 v17, v163, v171, v17
    v_dot2_f32_bf16 v16, v180, v188, v16
    v_dot2_f32_bf16 v17, v164, v172, v17
    v_dot2_f32_bf16 v16, v181, v189, v16
    v_dot2_f32_bf16 v17, v165, v173, v17
    v_dot2_f32_bf16 v16, v182, v190, v16
    v_dot2_f32_bf16 v17, v166, v174, v17
    v_dot2_f32_bf16 v16, v183, v191, v16
    v_dot2_f32_bf16 v17, v167, v175, v17
    s_nop 2
    v_add_f32 v16, v16, v17
    v_cvt_f64_f32 v[18:19], v16
    ds_add_f64 v21, v[18:19] offset:32768
    s_setprio 0
K2_W3:
    ds_read_b32 v33, v28 offset:36644
    s_waitcnt lgkmcnt(0)
    v_readfirstlane_b32 s77, v33
    s_cmp_lg_u32 s77, 8
    s_cbranch_scc1 K2_W3
K2_W4:
    ds_read_b128 v[96:99], v36 offset:0
    ds_read_b128 v[100:103], v36 offset:64
    ds_read_b128 v[104:107], v36 offset:128
    ds_read_b128 v[108:111], v36 offset:192
    ds_read_b128 v[112:115], v36 offset:4608
    ds_read_b128 v[116:119], v36 offset:4672
    ds_read_b128 v[120:123], v36 offset:4736
    ds_read_b128 v[124:127], v36 offset:4800
    ds_read_b128 v[224:227], v36 offset:9216
    ds_read_b128 v[228:231], v36 offset:9280
    ds_read_b128 v[232:235], v36 offset:9344
    ds_read_b128 v[236:239], v36 offset:9408
    s_waitcnt vmcnt(0)
    s_cmp_eq_u32 s50, 0
    s_cbranch_scc1 K2_FINAL
    s_add_u32 s47, s47, s48
    ds_read_b128 v[128:131], v36 offset:13824
    ds_read_b128 v[132:135], v36 offset:13888
    ds_read_b128 v[136:139], v36 offset:13952
    ds_read_b128 v[140:143], v36 offset:14016
    ds_read_b128 v[144:147], v36 offset:18432
    ds_read_b128 v[148:151], v36 offset:18496
    ds_read_b128 v[152:155], v36 offset:18560
    ds_read_b128 v[156:159], v36 offset:18624
    ds_read_b128 v[160:163], v36 offset:23040
    ds_read_b128 v[164:167], v36 offset:23104
    ds_read_b128 v[168:171], v36 offset:23168
    ds_read_b128 v[172:175], v36 offset:23232
    ds_read_b128 v[176:179], v36 offset:27648
    ds_read_b128 v[180:183], v36 offset:27712
    ds_read_b128 v[184:187], v36 offset:27776
    ds_read_b128 v[188:191], v36 offset:27840
    s_waitcnt lgkmcnt(0)
    v_mfma_f32_16x16x32_bf16 v[192:195], v[240:243], v[96:99], v[192:195]
    v_mfma_f32_16x16x32_bf16 v[192:195], v[244:247], v[100:103], v[192:195]
    v_mfma_f32_16x16x32_bf16 v[192:195], v[248:251], v[104:107], v[192:195]
    v_mfma_f32_16x16x32_bf16 v[192:195], v[252:255], v[108:111], v[192:195]
    v_mfma_f32_16x16x32_bf16 v[196:199], v[240:243], v[112:115], v[196:199]
    v_mfma_f32_16x16x32_bf16 v[196:199], v[244:247], v[116:119], v[196:199]
    v_mfma_f32_16x16x32_bf16 v[196:199], v[248:251], v[120:123], v[196:199]
    v_mfma_f32_16x16x32_bf16 v[196:199], v[252:255], v[124:127], v[196:199]
    v_mfma_f32_16x16x32_bf16 v[200:203], v[240:243], v[224:227], v[200:203]
    v_mfma_f32_16x16x32_bf16 v[200:203], v[244:247], v[228:231], v[200:203]
    v_mfma_f32_16x16x32_bf16 v[200:203], v[248:251], v[232:235], v[200:203]
    v_mfma_f32_16x16x32_bf16 v[200:203], v[252:255], v[236:239], v[200:203]
    v_mfma_f32_16x16x32_bf16 v[204:207], v[240:243], v[128:131], v[204:207]
    v_mfma_f32_16x16x32_bf16 v[204:207], v[244:247], v[132:135], v[204:207]
    v_mfma_f32_16x16x32_bf16 v[204:207], v[248:251], v[136:139], v[204:207]
    v_mfma_f32_16x16x32_bf16 v[204:207], v[252:255], v[140:143], v[204:207]
    v_mfma_f32_16x16x32_bf16 v[208:211], v[240:243], v[144:147], v[208:211]
    v_mfma_f32_16x16x32_bf16 v[208:211], v[244:247], v[148:151], v[208:211]
    v_mfma_f32_16x16x32_bf16 v[208:211], v[248:251], v[152:155], v[208:211]
    v_mfma_f32_16x16x32_bf16 v[208:211], v[252:255], v[156:159], v[208:211]
    v_mfma_f32_16x16x32_bf16 v[212:215], v[240:243], v[160:163], v[212:215]
    v_mfma_f32_16x16x32_bf16 v[212:215], v[244:247], v[164:167], v[212:215]
    v_mfma_f32_16x16x32_bf16 v[212:215], v[248:251], v[168:171], v[212:215]
    v_mfma_f32_16x16x32_bf16 v[212:215], v[252:255], v[172:175], v[212:215]
    v_mfma_f32_16x16x32_bf16 v[216:219], v[240:243], v[176:179], v[216:219]
    v_mfma_f32_16x16x32_bf16 v[216:219], v[244:247], v[180:183], v[216:219]
    v_mfma_f32_16x16x32_bf16 v[216:219], v[248:251], v[184:187], v[216:219]
    v_mfma_f32_16x16x32_bf16 v[216:219], v[252:255], v[188:191], v[216:219]
    v_lshlrev_b32 v16, 3, v0
    v_add_u32 v16, 56848, v16
    s_barrier
    ds_write_b64 v16, v[28:29] offset:0
    ds_write_b64 v16, v[28:29] offset:4096
    ds_write_b64 v16, v[28:29] offset:8192
    ds_write_b64 v16, v[28:29] offset:12288
    ds_write_b64 v16, v[28:29] offset:16384
    ds_write_b64 v16, v[28:29] offset:20480
    ds_write_b64 v16, v[28:29] offset:24576
    ds_write_b64 v16, v[28:29] offset:28672
K2_AGAIN:
    s_waitcnt vmcnt(0) lgkmcnt(0)
    s_barrier
    v_lshlrev_b32 v16, 3, v1
    ds_write_b64 v16, v[28:29] offset:36128
    ds_write_b64 v16, v[28:29] offset:36192
    s_lshr_b32 s77, s45, 2
    s_lshl_b32 s77, s77, 4
    s_and_b32 s78, s45, 1
    s_lshl_b32 s78, s78, 3
    s_add_u32 s77, s77, s78
    s_and_b32 s78, s45, 2
    s_lshl_b32 s78, s78, 9
    s_add_u32 s77, s77, s78
    s_add_u32 s77, s77, 6553600
    v_lshrrev_b32 v23, 1, v0
    v_lshl_add_u32 v12, v23, 11, s77
    s_mov_b32 s77, 7077888
    v_lshl_add_u32 v14, v23, 5, s77
    v_mul_u32_u24 v23, 18816, v23
    v_and_b32 v63, 1, v0
    v_lshlrev_b32 v63, 4, v63
    s_waitcnt lgkmcnt(0)
    s_barrier
    s_branch K2_B0
K2_FINAL:
    s_waitcnt lgkmcnt(8)
    v_mfma_f32_16x16x32_bf16 v[192:195], v[240:243], v[96:99], v[192:195]
    v_mfma_f32_16x16x32_bf16 v[192:195], v[244:247], v[100:103], v[192:195]
    v_mfma_f32_16x16x32_bf16 v[192:195], v[248:251], v[104:107], v[192:195]
    v_mfma_f32_16x16x32_bf16 v[192:195], v[252:255], v[108:111], v[192:195]
    ds_read_b128 v[128:131], v36 offset:13824
    ds_read_b128 v[132:135], v36 offset:13888
    ds_read_b128 v[136:139], v36 offset:13952
    ds_read_b128 v[140:143], v36 offset:14016
    s_waitcnt lgkmcnt(8)
    v_mfma_f32_16x16x32_bf16 v[196:199], v[240:243], v[112:115], v[196:199]
    v_mfma_f32_16x16x32_bf16 v[196:199], v[244:247], v[116:119], v[196:199]
    v_mfma_f32_16x16x32_bf16 v[196:199], v[248:251], v[120:123], v[196:199]
    v_mfma_f32_16x16x32_bf16 v[196:199], v[252:255], v[124:127], v[196:199]
    s_waitcnt lgkmcnt(4)
    v_mfma_f32_16x16x32_bf16 v[200:203], v[240:243], v[224:227], v[200:203]
    v_exp_f32 v48, v192
    v_mfma_f32_16x16x32_bf16 v[200:203], v[244:247], v[228:231], v[200:203]
    v_exp_f32 v49, v193
    v_mfma_f32_16x16x32_bf16 v[200:203], v[248:251], v[232:235], v[200:203]
    v_exp_f32 v50, v194
    v_mfma_f32_16x16x32_bf16 v[200:203], v[252:255], v[236:239], v[200:203]
    v_exp_f32 v51, v195
    v_exp_f32 v52, v196
    v_exp_f32 v53, v197
    v_exp_f32 v54, v198
    v_exp_f32 v55, v199
    ds_read_b128 v[144:147], v36 offset:18432
    ds_read_b128 v[148:151], v36 offset:18496
    ds_read_b128 v[152:155], v36 offset:18560
    ds_read_b128 v[156:159], v36 offset:18624
    ds_read_b128 v[160:163], v36 offset:23040
    ds_read_b128 v[164:167], v36 offset:23104
    ds_read_b128 v[168:171], v36 offset:23168
    ds_read_b128 v[172:175], v36 offset:23232
    v_pk_fma_f32 v[48:49], v[48:49], s[68:69], s[68:69]
    v_pk_fma_f32 v[50:51], v[50:51], s[68:69], s[68:69]
    v_pk_fma_f32 v[52:53], v[52:53], s[68:69], s[68:69]
    v_pk_fma_f32 v[54:55], v[54:55], s[68:69], s[68:69]
    s_waitcnt lgkmcnt(8)
    v_mfma_f32_16x16x32_bf16 v[204:207], v[240:243], v[128:131], v[204:207]
    v_rcp_f32 v48, v48
    v_mfma_f32_16x16x32_bf16 v[204:207], v[244:247], v[132:135], v[204:207]
    v_rcp_f32 v49, v49
    v_mfma_f32_16x16x32_bf16 v[204:207], v[248:251], v[136:139], v[204:207]
    v_rcp_f32 v50, v50
    v_mfma_f32_16x16x32_bf16 v[204:207], v[252:255], v[140:143], v[204:207]
    v_rcp_f32 v51, v51
    v_rcp_f32 v52, v52
    v_rcp_f32 v53, v53
    v_rcp_f32 v54, v54
    v_rcp_f32 v55, v55
    v_pk_fma_f32 v[48:49], v[48:49], v[192:193], v[64:65]
    v_pk_fma_f32 v[50:51], v[50:51], v[194:195], v[66:67]
    v_pk_fma_f32 v[52:53], v[52:53], v[196:197], v[68:69]
    v_pk_fma_f32 v[54:55], v[54:55], v[198:199], v[70:71]
    v_cvt_pk_bf16_f32 v192, v48, v49
    v_cvt_pk_bf16_f32 v193, v50, v51
    v_cvt_pk_bf16_f32 v194, v52, v53
    v_cvt_pk_bf16_f32 v195, v54, v55
    ds_write_b64 v37, v[192:193] offset:0
    ds_write_b64 v37, v[194:195] offset:4096
    ds_add_u32 v32, v34 offset:36688
    s_waitcnt lgkmcnt(7)
    v_mfma_f32_16x16x32_bf16 v[208:211], v[240:243], v[144:147], v[208:211]
    v_exp_f32 v48, v200
    v_mfma_f32_16x16x32_bf16 v[208:211], v[244:247], v[148:151], v[208:211]
    v_exp_f32 v49, v201
    v_mfma_f32_16x16x32_bf16 v[208:211], v[248:251], v[152:155], v[208:211]
    v_exp_f32 v50, v202
    v_mfma_f32_16x16x32_bf16 v[208:211], v[252:255], v[156:159], v[208:211]
    v_exp_f32 v51, v203
    v_exp_f32 v52, v204
    v_exp_f32 v53, v205
    v_exp_f32 v54, v206
    v_exp_f32 v55, v207
    ds_read_b128 v[176:179], v36 offset:27648
    ds_read_b128 v[180:183], v36 offset:27712
    ds_read_b128 v[184:187], v36 offset:27776
    ds_read_b128 v[188:191], v36 offset:27840
    v_pk_fma_f32 v[48:49], v[48:49], s[68:69], s[68:69]
    v_pk_fma_f32 v[50:51], v[50:51], s[68:69], s[68:69]
    v_pk_fma_f32 v[52:53], v[52:53], s[68:69], s[68:69]
    v_pk_fma_f32 v[54:55], v[54:55], s[68:69], s[68:69]
    s_waitcnt lgkmcnt(7)
    v_mfma_f32_16x16x32_bf16 v[212:215], v[240:243], v[160:163], v[212:215]
    v_rcp_f32 v48, v48
    v_mfma_f32_16x16x32_bf16 v[212:215], v[244:247], v[164:167], v[212:215]
    v_rcp_f32 v49, v49
    v_mfma_f32_16x16x32_bf16 v[212:215], v[248:251], v[168:171], v[212:215]
    v_rcp_f32 v50, v50
    v_mfma_f32_16x16x32_bf16 v[212:215], v[252:255], v[172:175], v[212:215]
    v_rcp_f32 v51, v51
    v_rcp_f32 v52, v52
    v_rcp_f32 v53, v53
    v_rcp_f32 v54, v54
    v_rcp_f32 v55, v55
    v_pk_fma_f32 v[48:49], v[48:49], v[200:201], v[72:73]
    v_pk_fma_f32 v[50:51], v[50:51], v[202:203], v[74:75]
    v_pk_fma_f32 v[52:53], v[52:53], v[204:205], v[76:77]
    v_pk_fma_f32 v[54:55], v[54:55], v[206:207], v[78:79]
    v_cvt_pk_bf16_f32 v200, v48, v49
    v_cvt_pk_bf16_f32 v201, v50, v51
    v_cvt_pk_bf16_f32 v202, v52, v53
    v_cvt_pk_bf16_f32 v203, v54, v55
    ds_write_b64 v37, v[200:201] offset:8192
    ds_write_b64 v37, v[202:203] offset:12288
    ds_add_u32 v32, v34 offset:36692
    s_waitcnt lgkmcnt(3)
    v_mfma_f32_16x16x32_bf16 v[216:219], v[240:243], v[176:179], v[216:219]
    v_exp_f32 v48, v208
    v_mfma_f32_16x16x32_bf16 v[216:219], v[244:247], v[180:183], v[216:219]
    v_exp_f32 v49, v209
    v_mfma_f32_16x16x32_bf16 v[216:219], v[248:251], v[184:187], v[216:219]
    v_exp_f32 v50, v210
    v_mfma_f32_16x16x32_bf16 v[216:219], v[252:255], v[188:191], v[216:219]
    v_exp_f32 v51, v211
    v_exp_f32 v52, v212
    v_exp_f32 v53, v213
    v_exp_f32 v54, v214
    v_exp_f32 v55, v215
    v_pk_fma_f32 v[48:49], v[48:49], s[68:69], s[68:69]
    v_pk_fma_f32 v[50:51], v[50:51], s[68:69], s[68:69]
    v_pk_fma_f32 v[52:53], v[52:53], s[68:69], s[68:69]
    v_pk_fma_f32 v[54:55], v[54:55], s[68:69], s[68:69]
    v_rcp_f32 v48, v48
    v_rcp_f32 v49, v49
    v_rcp_f32 v50, v50
    v_rcp_f32 v51, v51
    v_rcp_f32 v52, v52
    v_rcp_f32 v53, v53
    v_rcp_f32 v54, v54
    v_rcp_f32 v55, v55
    v_pk_fma_f32 v[48:49], v[48:49], v[208:209], v[80:81]
    v_pk_fma_f32 v[50:51], v[50:51], v[210:211], v[82:83]
    v_pk_fma_f32 v[52:53], v[52:53], v[212:213], v[84:85]
    v_pk_fma_f32 v[54:55], v[54:55], v[214:215], v[86:87]
    v_cvt_pk_bf16_f32 v208, v48, v49
    v_cvt_pk_bf16_f32 v209, v50, v51
    v_cvt_pk_bf16_f32 v210, v52, v53
    v_cvt_pk_bf16_f32 v211, v54, v55
    ds_write_b64 v37, v[208:209] offset:16384
    ds_write_b64 v37, v[210:211] offset:20480
    ds_add_u32 v32, v34 offset:36696
    v_exp_f32 v48, v216
    v_exp_f32 v49, v217
    v_exp_f32 v50, v218
    v_exp_f32 v51, v219
    v_pk_fma_f32 v[48:49], v[48:49], s[68:69], s[68:69]
    v_pk_fma_f32 v[50:51], v[50:51], s[68:69], s[68:69]
    v_rcp_f32 v48, v48
    v_rcp_f32 v49, v49
    v_rcp_f32 v50, v50
    v_rcp_f32 v51, v51
    v_pk_fma_f32 v[48:49], v[48:49], v[216:217], v[88:89]
    v_pk_fma_f32 v[50:51], v[50:51], v[218:219], v[90:91]
    v_cvt_pk_bf16_f32 v216, v48, v49
    v_cvt_pk_bf16_f32 v217, v50, v51
    ds_write_b64 v37, v[216:217] offset:24576
    ds_add_u32 v32, v34 offset:36700
    s_lshr_b32 s77, s44, 1
    s_lshl_b32 s77, s77, 2
    v_mov_b32 v32, s77
K2_W5:
    ds_read_b32 v33, v32 offset:36688
    ds_read_b128 v[128:131], v44 offset:0
    ds_read_b128 v[132:135], v44 offset:1024
    ds_read_b128 v[136:139], v44 offset:2048
    ds_read_b128 v[140:143], v44 offset:3072
    ds_read_b64 v[56:57], v47 offset:32776
    ds_read_b32 v58, v46 offset:37216
    s_waitcnt lgkmcnt(6)
    v_readfirstlane_b32 s77, v33
    s_cmp_eq_u32 s77, 8
    s_cbranch_scc1 K2_W6
K2_W7:
    ds_read_b32 v33, v32 offset:36688
    s_waitcnt lgkmcnt(0)
    v_readfirstlane_b32 s77, v33
    s_cmp_eq_u32 s77, 8
    s_cbranch_scc1 K2_W5
    s_branch K2_W7
K2_W6:
    s_waitcnt lgkmcnt(5)
    buffer_store_dwordx4 v[128:131], v40, s[36:39], 0 offen offset:0 nt
    s_waitcnt lgkmcnt(4)
    buffer_store_dwordx4 v[132:135], v41, s[36:39], 0 offen offset:1024 nt
    s_waitcnt lgkmcnt(3)
    buffer_store_dwordx4 v[136:139], v42, s[36:39], 0 offen offset:2048 nt
    s_waitcnt lgkmcnt(2)
    buffer_store_dwordx4 v[140:143], v43, s[36:39], 0 offen offset:3072 nt
    s_waitcnt lgkmcnt(0)
    v_cvt_f32_f64 v56, v[56:57]
    v_fma_f32 v56, v56, s70, v58
    v_cvt_pk_bf16_f32 v56, v56, v56
    buffer_store_short v56, v45, s[16:19], 0 offen
K2_END:
    s_endpgm
.section .rodata,"a"
.p2align 6
.amdhsa_kernel standalone__cheap_equivariant_egnn__graph_kernel
  .amdhsa_next_free_vgpr 256
  .amdhsa_next_free_sgpr 102
  .amdhsa_accum_offset 256
  .amdhsa_group_segment_fixed_size 0
  .amdhsa_kernarg_size 88
  .amdhsa_user_sgpr_count 2
  .amdhsa_user_sgpr_kernarg_segment_ptr 1
  .amdhsa_system_sgpr_workgroup_id_x 1
.end_amdhsa_kernel
```
